```python
import torch

def _softmax(x, axis=-1):
    return torch.softmax(x, dim=axis)
def _gelu(x):
    return torch.nn.functional.gelu(x, approximate="tanh")
def _silu(x):
    return torch.nn.functional.silu(x)
def _sigmoid(x):
    return torch.sigmoid(x)
def _layernorm(x, axis=-1, eps=1e-5):
    m = x.mean(dim=axis, keepdim=True)
    v = x.var(dim=axis, keepdim=True, unbiased=False)
    return (x - m) / torch.sqrt(v + eps)
def _scatter_add(tgt, idx, src, axis=0):
    return tgt.clone().index_add_(axis, idx, src)
def _segment_sum(src, seg, n):
    out = torch.zeros((n,) + src.shape[1:], dtype=src.dtype)
    return out.index_add_(0, seg, src)
def _pad(x, pw):
    flat = tuple(v for pair in reversed(pw) for v in pair)
    return torch.nn.functional.pad(x, flat)

kernel_name = 'interleave_layers__sliding_block_cached__swiglu_ffn__decode'

def setup_inputs():

    _w = (lambda a: (lambda t: t.to(torch.bfloat16) if t.is_floating_point() else t)(torch.as_tensor(a)))
    def _A_setup():
        B, Sq, D = 1, 1, 448
        Hq, Hkv, Sk, Dh = 16, 8, 65536, 256
        assert Hq % Hkv == 0, (Hq, Hkv)
        return {
            "x": _w((lambda *s: torch.randn(*s, dtype=torch.bfloat16) * 0.05)(B, Sq, D)),
            "k_cache": _w((lambda *s: torch.randn(*s, dtype=torch.bfloat16) * 1.6)(B, Hkv, Sk, Dh)),
            "v_cache": _w((lambda *s: torch.randn(*s, dtype=torch.bfloat16) * 1.6)(B, Hkv, Sk, Dh)),
            "wq": _w((lambda *s: torch.randn(*s, dtype=torch.bfloat16) * 1.6)(D, Hq * Dh) * (D ** -0.5)),
            "wo": _w((lambda *s: torch.randn(*s, dtype=torch.bfloat16) * 1.6)(Hq * Dh, D) * ((Hq * Dh) ** -0.5)),
        }
    _A_in = _A_setup()

    def _B_setup():
        B, S, D, F = 1, 1, 448, 1792
        return {
            "x": _w((lambda *s: torch.randn(*s, dtype=torch.bfloat16) * 0.05)(B, S, D)),
            "w_gate": _w((lambda *s: torch.randn(*s, dtype=torch.bfloat16) * 0.05)(D, F)),
            "w_up": _w((lambda *s: torch.randn(*s, dtype=torch.bfloat16) * 0.05)(D, F)),
            "w_down": _w((lambda *s: torch.randn(*s, dtype=torch.bfloat16) * 0.05)(F, D)),
        }
    _B_in = _B_setup()

    return {
        "A_x": _A_in["x"],
        "A_k_cache": _A_in["k_cache"],
        "A_v_cache": _A_in["v_cache"],
        "A_wq": _A_in["wq"],
        "A_wo": _A_in["wo"],
        "B_x": _B_in["x"],
        "B_w_gate": _B_in["w_gate"],
        "B_w_up": _B_in["w_up"],
        "B_w_down": _B_in["w_down"],
    }

def reference(A_x, A_k_cache, A_v_cache, A_wq, A_wo, B_x, B_w_gate, B_w_up, B_w_down):
    def _A_ref(x, k_cache, v_cache, wq, wo):
        B, Sq, D = x.shape
        Hq, Dh = 16, 256
        Hkv, Sk = k_cache.shape[1], k_cache.shape[2]
        W = min(4096, max(256, Sk // 4))
        rep = Hq // Hkv
        q = (lambda x, *d: x.permute(*d))((x @ wq).reshape(B, Sq, Hq, Dh), 0, 2, 1, 3)
        k = (lambda x, n, axis: torch.repeat_interleave(x, n, dim=axis))(k_cache[:, :, Sk - W:, :], rep, axis=1)
        v = (lambda x, n, axis: torch.repeat_interleave(x, n, dim=axis))(v_cache[:, :, Sk - W:, :], rep, axis=1)
        scores = torch.einsum("bhqd,bhkd->bhqk", q, k) * (Dh ** -0.5)
        p = _softmax(scores, axis=-1)
        o = torch.einsum("bhqk,bhkd->bhqd", p, v)
        return (lambda x, *d: x.permute(*d))(o, 0, 2, 1, 3).reshape(B, Sq, Hq * Dh) @ wo

    def _B_ref(x, w_gate, w_up, w_down):
        g = _silu(x @ w_gate)
        u = x @ w_up
        return (g * u) @ w_down

    x = A_x
    x = x + _A_ref(_layernorm(x, axis=-1), A_k_cache, A_v_cache, A_wq, A_wo)
    x = x + _B_ref(_layernorm(x, axis=-1), B_w_gate, B_w_up, B_w_down)
    x = x + _A_ref(_layernorm(x, axis=-1), A_k_cache, A_v_cache, A_wq, A_wo)
    x = x + _B_ref(_layernorm(x, axis=-1), B_w_gate, B_w_up, B_w_down)
    return x
```

```asm
; @launch grid=(256,1,1) block=(256,1,1) lds=135424
.amdgcn_target "amdgcn-amd-amdhsa--gfx950"
.text
.globl interleave_layers__sliding_block_cached__swiglu_ffn__decode_kernel
.p2align 8
.type interleave_layers__sliding_block_cached__swiglu_ffn__decode_kernel,@function
interleave_layers__sliding_block_cached__swiglu_ffn__decode_kernel:
    s_cmp_ge_u32 s2, 256
    s_cbranch_scc1 L_bail
    s_load_dwordx16 s[4:19], s[0:1], 0
    s_load_dwordx8 s[20:27], s[0:1], 64
    s_getpc_b64 s[44:45]
L_pc:
    s_sub_u32 s44, s44, L_pc-interleave_layers__sliding_block_cached__swiglu_ffn__decode_kernel
    s_subb_u32 s45, s45, 0
    s_lshr_b32 s46, s2, 3
    s_mul_i32 s46, s46, 0x3334
    s_lshr_b32 s46, s46, 16
    s_mul_i32 s46, s46, 5
    s_lshr_b32 s47, s2, 3
    s_sub_u32 s46, s47, s46
    s_lshl_b32 s46, s46, 12
    v_lshl_add_u32 v69, v0, 4, s46
    v_min_u32 v69, L_code_end-interleave_layers__sliding_block_cached__swiglu_ffn__decode_kernel-16, v69
    global_load_dwordx4 v[112:115], v69, s[44:45]
    v_lshrrev_b32 v56, 6, v0
    v_and_b32 v1, 63, v0
    v_and_b32 v2, 15, v0
    v_readfirstlane_b32 s30, v56
    v_bfe_u32 v3, v0, 4, 2
    v_mov_b32 v13, 0
    v_mov_b32 v20, 0
    v_mov_b32 v71, 0
    v_mov_b32 v145, 0
    s_and_b32 s28, s2, 7
    s_lshr_b32 s29, s2, 3
    s_min_u32 s35, s29, 27
    s_and_b32 s33, s35, 3
    s_lshr_b32 s34, s35, 2
    s_lshl_b32 s35, s28, 25
    s_lshl_b32 s36, s29, 16
    s_add_u32 s35, s35, s36
    s_lshl_b32 s47, s30, 14
    s_add_u32 s35, s35, s47
    s_add_u32 s35, s35, 0x1e00000
    v_lshlrev_b32 v133, 9, v2
    v_lshl_add_u32 v133, v3, 4, v133
    v_add_u32 v134, 0x2000, v133
    v_lshrrev_b32 v135, 3, v1
    v_and_b32 v62, 7, v1
    v_lshlrev_b32 v62, 4, v62
    v_lshl_add_u32 v135, v135, 9, v62
    v_add_u32 v136, 0x1000, v135
    v_add_u32 v137, 0x2000, v135
    v_add_u32 v138, 0x3000, v135
    s_waitcnt lgkmcnt(0)
    s_add_u32 s40, s6, s35
    s_addc_u32 s41, s7, 0
    s_add_u32 s42, s8, s35
    s_addc_u32 s43, s9, 0
    s_sub_u32 s58, s42, s47
    s_subb_u32 s59, s43, 0
    s_getreg_b32 s31, hwreg(HW_REG_XCC_ID)
    s_and_b32 s31, s31, 7
    s_lshl_b32 s35, s28, 3
    s_or_b32 s31, s31, s35
    s_or_b32 s31, s31, 0x80
    s_sub_u32 s60, s30, 1
    s_mul_i32 s60, s60, 6
    s_cmp_eq_u32 s30, 0
    s_cbranch_scc1 L_ld_w0
    s_cmp_eq_u32 s30, 1
    s_cbranch_scc1 L_ld_w1
L_ld_str:
    s_add_u32 s61, s60, 0
    s_min_u32 s61, s61, 15
    s_and_b32 s62, s61, 3
    s_lshr_b32 s63, s61, 2
    s_lshl_b32 s61, s62, 2
    s_add_u32 s61, s61, s63
    s_lshl_b32 m0, s61, 10
    s_lshl_b32 s62, s62, 7
    s_lshl_b32 s63, s63, 12
    s_add_u32 s62, s62, s63
    s_add_u32 s44, s58, s62
    s_addc_u32 s45, s59, 0
    global_load_lds_dwordx4 v135, s[44:45] nt
    s_add_u32 s61, s60, 1
    s_min_u32 s61, s61, 15
    s_and_b32 s62, s61, 3
    s_lshr_b32 s63, s61, 2
    s_lshl_b32 s61, s62, 2
    s_add_u32 s61, s61, s63
    s_lshl_b32 m0, s61, 10
    s_lshl_b32 s62, s62, 7
    s_lshl_b32 s63, s63, 12
    s_add_u32 s62, s62, s63
    s_add_u32 s44, s58, s62
    s_addc_u32 s45, s59, 0
    global_load_lds_dwordx4 v135, s[44:45] nt
    s_add_u32 s61, s60, 2
    s_min_u32 s61, s61, 15
    s_and_b32 s62, s61, 3
    s_lshr_b32 s63, s61, 2
    s_lshl_b32 s61, s62, 2
    s_add_u32 s61, s61, s63
    s_lshl_b32 m0, s61, 10
    s_lshl_b32 s62, s62, 7
    s_lshl_b32 s63, s63, 12
    s_add_u32 s62, s62, s63
    s_add_u32 s44, s58, s62
    s_addc_u32 s45, s59, 0
    global_load_lds_dwordx4 v135, s[44:45] nt
    s_add_u32 s61, s60, 3
    s_min_u32 s61, s61, 15
    s_and_b32 s62, s61, 3
    s_lshr_b32 s63, s61, 2
    s_lshl_b32 s61, s62, 2
    s_add_u32 s61, s61, s63
    s_lshl_b32 m0, s61, 10
    s_lshl_b32 s62, s62, 7
    s_lshl_b32 s63, s63, 12
    s_add_u32 s62, s62, s63
    s_add_u32 s44, s58, s62
    s_addc_u32 s45, s59, 0
    global_load_lds_dwordx4 v135, s[44:45] nt
    s_add_u32 s61, s60, 4
    s_min_u32 s61, s61, 15
    s_and_b32 s62, s61, 3
    s_lshr_b32 s63, s61, 2
    s_lshl_b32 s61, s62, 2
    s_add_u32 s61, s61, s63
    s_lshl_b32 m0, s61, 10
    s_lshl_b32 s62, s62, 7
    s_lshl_b32 s63, s63, 12
    s_add_u32 s62, s62, s63
    s_add_u32 s44, s58, s62
    s_addc_u32 s45, s59, 0
    global_load_lds_dwordx4 v135, s[44:45] nt
    s_add_u32 s61, s60, 5
    s_min_u32 s61, s61, 15
    s_and_b32 s62, s61, 3
    s_lshr_b32 s63, s61, 2
    s_lshl_b32 s61, s62, 2
    s_add_u32 s61, s61, s63
    s_lshl_b32 m0, s61, 10
    s_lshl_b32 s62, s62, 7
    s_lshl_b32 s63, s63, 12
    s_add_u32 s62, s62, s63
    s_add_u32 s44, s58, s62
    s_addc_u32 s45, s59, 0
    global_load_lds_dwordx4 v135, s[44:45] nt
    s_branch L_ld_done
L_ld_w1:
    v_mov_b32 v64, -1
    v_mov_b32 v65, -1
    v_mov_b32 v66, -1
    v_mov_b32 v67, -1
    v_lshlrev_b32 v68, 4, v1
    v_lshlrev_b32 v70, 2, v1
    global_load_dword v75, v70, s[24:25] sc1
    s_lshl_b32 s35, s28, 11
    v_add_u32 v69, s35, v68
    global_load_dwordx4 v[76:79], v69, s[26:27] offset:0 sc1
    global_load_dwordx4 v[76:79], v69, s[26:27] offset:1024 sc1
    s_lshl_b32 s35, s28, 10
    s_add_u32 s35, s35, 0x4000
    v_add_u32 v69, s35, v68
    global_load_dwordx4 v[76:79], v69, s[26:27] sc1
    v_add_u32 v69, 0x2000, v69
    global_load_dwordx4 v[76:79], v69, s[26:27] sc1
    s_lshl_b32 s35, s28, 12
    s_add_u32 s35, s35, 0x8000
    v_add_u32 v69, s35, v68
    global_load_dwordx4 v[76:79], v69, s[26:27] sc1
    global_load_dwordx4 v[76:79], v69, s[26:27] offset:1024 sc1
    global_load_dwordx4 v[76:79], v69, s[26:27] offset:2048 sc1
    s_cmp_ge_u32 s29, 28
    s_cbranch_scc1 L_rst_noxb
    s_lshl_b32 s35, s34, 14
    s_lshl_b32 s36, s28, 9
    s_add_u32 s35, s35, s36
    s_lshl_b32 s36, s33, 7
    s_add_u32 s35, s35, s36
    s_add_u32 s35, s35, 0x10000
    v_bfe_u32 v69, v1, 3, 1
    v_lshlrev_b32 v69, 13, v69
    v_lshl_add_u32 v69, v3, 12, v69
    v_add3_u32 v69, v69, v62, s35
    s_mov_b64 exec, 0xffffffff
    global_store_dwordx4 v69, v[64:67], s[26:27] sc1
    s_mov_b64 exec, -1
    s_nop 0
L_rst_noxb:
    s_cmp_ge_u32 s29, 14
    s_cbranch_scc1 L_rst_done
    s_lshl_b32 s35, s29, 11
    s_lshl_b32 s36, s28, 7
    s_add_u32 s35, s35, s36
    s_add_u32 s35, s35, 0x180000
    v_lshrrev_b32 v69, 3, v1
    v_lshlrev_b32 v69, 15, v69
    v_add3_u32 v69, v69, v62, s35
    global_store_dwordx4 v69, v[64:67], s[26:27] sc1
    global_store_dwordx4 v69, v[64:67], s[26:27] offset:1024 sc1
    s_nop 1
L_rst_done:
    s_min_u32 s35, s29, 13
    s_lshl_b32 s35, s35, 6
    v_and_b32 v69, 7, v1
    v_lshlrev_b32 v69, 3, v69
    v_lshrrev_b32 v70, 5, v1
    v_lshl_add_u32 v69, v70, 2, v69
    v_add_u32 v71, s35, v69
    global_load_dword v76, v71, s[22:23]
    global_load_dword v75, v71, s[4:5]
    s_branch L_ld_str
L_ld_w0:
    v_mov_b32 v64, -1
    v_mov_b32 v65, -1
    v_mov_b32 v66, -1
    v_mov_b32 v67, -1
    s_lshl_b32 s35, s28, 11
    s_lshl_b32 s36, s29, 5
    s_add_u32 s35, s35, s36
    s_add_u32 s35, s35, 0x0
    v_lshl_add_u32 v69, v1, 4, s35
    s_mov_b64 exec, 0x3
    global_store_dwordx4 v69, v[64:67], s[26:27]
    s_mov_b64 exec, -1
    s_nop 0
    v_lshl_add_u32 v64, v2, 2, v3
    v_min_u32 v64, 55, v64
    v_lshlrev_b32 v64, 4, v64
    global_load_dwordx4 v[24:27], v64, s[4:5]
    s_lshl_b32 s35, s28, 10
    s_lshl_b32 s36, s29, 5
    s_add_u32 s35, s35, s36
    s_add_u32 s44, s10, s35
    s_addc_u32 s45, s11, 0
    v_lshrrev_b32 v65, 1, v1
    v_lshlrev_b32 v65, 13, v65
    v_and_b32 v66, 1, v1
    v_lshl_add_u32 v65, v66, 4, v65
    s_mov_b32 m0, 65536
    s_nop 0
    global_load_lds_dwordx4 v65, s[44:45] nt
    s_add_u32 s44, s44, 262144
    s_addc_u32 s45, s45, 0
    s_mov_b32 m0, 66560
    s_nop 0
    global_load_lds_dwordx4 v65, s[44:45] nt
    s_add_u32 s44, s44, 262144
    s_addc_u32 s45, s45, 0
    s_mov_b32 m0, 67584
    s_nop 0
    global_load_lds_dwordx4 v65, s[44:45] nt
    s_add_u32 s44, s44, 262144
    s_addc_u32 s45, s45, 0
    s_mov_b32 m0, 68608
    s_nop 0
    global_load_lds_dwordx4 v65, s[44:45] nt
    s_add_u32 s44, s44, 262144
    s_addc_u32 s45, s45, 0
    s_mov_b32 m0, 69632
    s_nop 0
    global_load_lds_dwordx4 v65, s[44:45] nt
    s_add_u32 s44, s44, 262144
    s_addc_u32 s45, s45, 0
    s_mov_b32 m0, 70656
    s_nop 0
    global_load_lds_dwordx4 v65, s[44:45] nt
    s_add_u32 s44, s44, 262144
    s_addc_u32 s45, s45, 0
    s_mov_b32 m0, 71680
    s_nop 0
    global_load_lds_dwordx4 v65, s[44:45] nt
    s_add_u32 s44, s44, 262144
    s_addc_u32 s45, s45, 0
    s_mov_b32 m0, 72704
    s_nop 0
    global_load_lds_dwordx4 v65, s[44:45] nt
    s_add_u32 s44, s44, 262144
    s_addc_u32 s45, s45, 0
    s_mov_b32 m0, 73728
    s_nop 0
    global_load_lds_dwordx4 v65, s[44:45] nt
    s_add_u32 s44, s44, 262144
    s_addc_u32 s45, s45, 0
    s_mov_b32 m0, 74752
    s_nop 0
    global_load_lds_dwordx4 v65, s[44:45] nt
    s_add_u32 s44, s44, 262144
    s_addc_u32 s45, s45, 0
    s_mov_b32 m0, 75776
    s_nop 0
    global_load_lds_dwordx4 v65, s[44:45] nt
    s_add_u32 s44, s44, 262144
    s_addc_u32 s45, s45, 0
    s_mov_b32 m0, 76800
    s_nop 0
    global_load_lds_dwordx4 v65, s[44:45] nt
    s_add_u32 s44, s44, 262144
    s_addc_u32 s45, s45, 0
    s_mov_b32 m0, 77824
    s_nop 0
    global_load_lds_dwordx4 v65, s[44:45] nt
    s_add_u32 s44, s44, 262144
    s_addc_u32 s45, s45, 0
    s_mov_b32 m0, 78848
    s_nop 0
    global_load_lds_dwordx4 v65, s[44:45] nt
    s_lshl_b32 s35, s29, 2
    v_mov_b32 v145, s35
    v_mov_b32 v70, s31
    s_waitcnt vmcnt(15)
    s_mov_b64 exec, 1
    global_store_dword v145, v70, s[24:25] offset:128
    s_mov_b64 exec, -1
    v_mov_b32 v64, -1
    v_mov_b32 v65, -1
    v_mov_b32 v66, -1
    v_mov_b32 v67, -1
    s_mul_i32 s35, s28, 81920
    s_mul_i32 s36, s29, 2176
    s_add_u32 s35, s35, s36
    s_add_u32 s35, s35, 0x40000
    v_lshl_add_u32 v69, v1, 4, s35
    global_store_dwordx4 v69, v[64:67], s[26:27]
    global_store_dwordx4 v69, v[64:67], s[26:27] offset:1024
    s_lshl_b32 s35, s28, 10
    s_lshl_b32 s36, s29, 3
    s_add_u32 s35, s35, s36
    s_add_u32 s35, s35, 0x4000
    v_lshl_add_u32 v69, v1, 8, s35
    s_mov_b64 exec, 0xf
    global_store_dwordx2 v69, v[64:65], s[26:27]
    s_lshl_b32 s35, s28, 11
    s_lshl_b32 s36, s29, 5
    s_add_u32 s35, s35, s36
    s_add_u32 s35, s35, 0x0
    v_lshrrev_b32 v69, 1, v1
    v_lshlrev_b32 v69, 10, v69
    v_and_b32 v70, 1, v1
    v_lshl_add_u32 v69, v70, 4, v69
    v_add_u32 v69, s35, v69
    s_mov_b64 exec, 0xc
    global_store_dwordx4 v69, v[64:67], s[26:27]
    s_mov_b64 exec, 0xf
    s_lshl_b32 s35, s28, 10
    s_lshl_b32 s36, s29, 4
    s_add_u32 s35, s35, s36
    s_add_u32 s35, s35, 0x6000
    v_lshl_add_u32 v69, v1, 9, s35
    s_mov_b64 exec, 0x3
    global_store_dwordx4 v69, v[64:67], s[26:27]
    s_lshl_b32 s35, s28, 12
    s_and_b32 s36, s29, 15
    s_lshl_b32 s36, s36, 6
    s_add_u32 s35, s35, s36
    s_add_u32 s35, s35, 0x8000
    s_cmp_lt_u32 s29, 14
    s_mov_b32 s57, 0xf000
    s_cselect_b32 s56, 0xfff, s57
    s_mov_b32 s57, 0
    s_mov_b64 exec, -1
    v_lshrrev_b32 v69, 2, v1
    v_lshlrev_b32 v69, 10, v69
    v_and_b32 v70, 3, v1
    v_lshl_add_u32 v69, v70, 4, v69
    v_add_u32 v69, s35, v69
    s_mov_b64 exec, s[56:57]
    global_store_dwordx4 v69, v[64:67], s[26:27]
    s_mov_b64 exec, -1
    global_load_dwordx4 a[0:3], v133, s[40:41] offset:0 nt
    global_load_dwordx4 a[4:7], v133, s[40:41] offset:64 nt
    global_load_dwordx4 a[8:11], v133, s[40:41] offset:128 nt
    global_load_dwordx4 a[12:15], v133, s[40:41] offset:192 nt
    global_load_dwordx4 a[16:19], v133, s[40:41] offset:256 nt
    global_load_dwordx4 a[20:23], v133, s[40:41] offset:320 nt
    global_load_dwordx4 a[24:27], v133, s[40:41] offset:384 nt
    global_load_dwordx4 a[28:31], v133, s[40:41] offset:448 nt
    global_load_dwordx4 a[32:35], v134, s[40:41] offset:0 nt
    global_load_dwordx4 a[36:39], v134, s[40:41] offset:64 nt
    global_load_dwordx4 a[40:43], v134, s[40:41] offset:128 nt
    global_load_dwordx4 a[44:47], v134, s[40:41] offset:192 nt
    global_load_dwordx4 a[48:51], v134, s[40:41] offset:256 nt
    global_load_dwordx4 a[52:55], v134, s[40:41] offset:320 nt
    global_load_dwordx4 a[56:59], v134, s[40:41] offset:384 nt
    global_load_dwordx4 a[60:63], v134, s[40:41] offset:448 nt
L_ld_done:
    v_mov_b32 v48, 0x3f803f80
    v_mov_b32 v49, 0x3f803f80
    v_mov_b32 v50, 0x3f803f80
    v_mov_b32 v51, 0x3f803f80
    v_mov_b32 v21, 0x3b124925
    s_mov_b32 s48, 0x3fff3fff
    s_mov_b32 s49, 0x3fff3fff
    s_mov_b32 s52, 0x3db8aa3b
    s_lshl_b32 s35, s28, 11
    s_add_u32 s35, s35, 0x0
    v_and_b32 v64, 1, v2
    v_lshlrev_b32 v64, 9, v64
    v_lshrrev_b32 v65, 1, v2
    v_lshl_add_u32 v64, v65, 6, v64
    v_lshl_add_u32 v64, v3, 4, v64
    v_add_u32 v4, s35, v64
    s_mul_i32 s35, s28, 81920
    s_add_u32 s35, s35, 0x40000
    s_mul_i32 s36, s29, 2176
    s_add_u32 s36, s36, s35
    s_lshl_b32 s37, s30, 7
    s_add_u32 s36, s36, s37
    v_and_b32 v64, 1, v2
    v_lshlrev_b32 v64, 9, v64
    v_lshl_add_u32 v64, v3, 4, v64
    v_add_u32 v5, s36, v64
    s_lshl_b32 s36, s33, 8
    s_add_u32 s35, s35, s36
    s_lshl_b32 s36, s30, 7
    s_add_u32 s35, s35, s36
    v_mul_u32_u24 v64, 2176, v2
    v_lshl_add_u32 v64, v3, 4, v64
    v_add_u32 v7, s35, v64
    v_add_u32 v8, 34816, v7
    s_lshl_b32 s35, s28, 10
    s_add_u32 s35, s35, 0x4000
    s_lshl_b32 s37, s29, 3
    s_add_u32 s36, s37, s35
    v_and_b32 v64, 1, v2
    v_lshl_add_u32 v6, v64, 8, s36
    s_lshr_b32 s36, s33, 1
    s_lshl_b32 s36, s36, 8
    s_add_u32 s35, s35, s36
    v_and_b32 v64, 3, v2
    v_lshl_add_u32 v64, v3, 2, v64
    v_bfe_u32 v65, v2, 2, 1
    v_lshl_add_u32 v64, v65, 4, v64
    v_lshl_add_u32 v9, v64, 3, s35
    s_lshl_b32 s35, s34, 14
    s_lshl_b32 s36, s28, 9
    s_add_u32 s35, s35, s36
    s_lshl_b32 s36, s33, 7
    s_add_u32 s35, s35, s36
    s_add_u32 s35, s35, 0x10800
    v_lshrrev_b32 v64, 5, v1
    v_lshlrev_b32 v64, 13, v64
    v_and_b32 v65, 31, v1
    v_lshl_add_u32 v64, v65, 2, v64
    v_add_u32 v10, s35, v64
    v_and_b32 v64, 1, v2
    v_lshlrev_b32 v65, 6, v64
    v_lshl_add_u32 v65, v3, 4, v65
    v_add_u32 v15, 124928, v65
    s_lshl_b32 s35, s30, 7
    v_add_u32 v14, s35, v15
    v_lshlrev_b32 v64, 4, v64
    v_add_u32 v144, 133120, v64
    s_lshl_b32 s35, s30, 2
    v_add_u32 v16, s35, v144
    v_and_b32 v64, 1, v2
    v_lshlrev_b32 v64, 4, v64
    v_lshl_add_u32 v64, v3, 8, v64
    v_add_u32 v146, 133184, v64
    v_lshlrev_b32 v64, 4, v1
    v_add_u32 v22, 133184, v64
    v_lshlrev_b32 v64, 2, v1
    v_add_u32 v23, 134272, v64
    v_mov_b32 v64, -1
    ds_write_b32 v23, v64
    ds_write_b32 v23, v64 offset:256
    s_min_u32 s38, s29, 13
    v_lshl_add_u32 v64, v2, 2, v3
    s_cmp_eq_u32 s30, 1
    s_cbranch_scc1 L_ad_w1
    s_cmp_eq_u32 s30, 2
    s_cbranch_scc1 L_ad_w2
    s_lshl_b32 s35, s28, 12
    s_add_u32 s35, s35, 0x8000
    v_min_u32 v64, 55, v64
    v_lshl_add_u32 v11, v64, 4, s35
    v_lshrrev_b32 v65, 1, v2
    s_cmp_eq_u32 s30, 3
    s_cbranch_scc1 L_ad_w3
    s_lshl_b32 s35, s28, 11
    s_lshl_b32 s36, s29, 5
    s_add_u32 s35, s35, s36
    s_add_u32 s35, s35, 0x0
    v_lshl_add_u32 v12, v65, 2, s35
    s_branch L_ad_done
L_ad_w3:
    s_lshl_b32 s35, s28, 10
    s_lshl_b32 s36, s29, 4
    s_add_u32 s35, s35, s36
    s_add_u32 s35, s35, 0x6000
    v_lshl_add_u32 v12, v65, 2, s35
    s_branch L_ad_done
L_ad_w2:
    s_lshl_b32 s35, s28, 10
    s_add_u32 s35, s35, 0x6000
    v_min_u32 v64, 27, v64
    v_lshl_add_u32 v11, v64, 4, s35
    s_lshl_b32 s35, s38, 11
    s_lshl_b32 s36, s28, 7
    s_add_u32 s35, s35, s36
    s_add_u32 s35, s35, 0x180000
    v_and_b32 v65, 31, v1
    v_lshl_add_u32 v12, v65, 2, s35
    v_lshrrev_b32 v65, 5, v1
    v_lshl_add_u32 v12, v65, 15, v12
    s_branch L_ad_done
L_ad_w1:
    s_lshl_b32 s35, s38, 13
    s_add_u32 s35, s35, 0x11000
    v_lshl_add_u32 v11, v1, 4, s35
    s_lshl_b32 s35, s38, 11
    s_add_u32 s35, s35, 0x180000
    s_lshl_b32 s36, s28, 15
    s_add_u32 s35, s35, s36
    v_lshl_add_u32 v13, v1, 4, s35
    s_lshl_b32 s35, s28, 12
    s_add_u32 s35, s35, 0x8000
    v_add_u32 v12, s35, v71
    v_mov_b32 v20, v71
L_ad_done:
    v_lshrrev_b32 v64, 2, v2
    v_and_b32 v65, 3, v2
    s_lshl_b32 s35, s30, 12
    v_lshl_add_u32 v66, v3, 2, v64
    v_lshlrev_b32 v66, 7, v66
    v_lshl_add_u32 v66, v65, 4, v66
    v_add_u32 v17, s35, v66
    s_and_b32 s35, s30, 1
    s_lshl_b32 s35, s35, 13
    s_add_u32 s35, s35, 94208
    v_lshl_add_u32 v66, v3, 3, v64
    v_lshlrev_b32 v66, 7, v66
    v_lshl_add_u32 v66, v65, 3, v66
    v_add_u32 v128, s35, v66
    s_cmp_eq_u32 s30, 2
    s_cbranch_scc1 L_tb_w2
    s_cmp_eq_u32 s30, 3
    s_cbranch_scc1 L_tb_w3
    v_lshl_add_u32 v66, v3, 3, v64
    v_lshlrev_b32 v66, 5, v66
    v_lshl_add_u32 v66, v65, 3, v66
    v_add_u32 v129, 65536, v66
    s_branch L_tb_done
L_tb_w2:
    v_lshl_add_u32 v66, v3, 3, v64
    v_lshlrev_b32 v66, 6, v66
    v_lshl_add_u32 v66, v65, 3, v66
    v_add_u32 v129, 110592, v66
    s_branch L_tb_done
L_tb_w3:
    v_lshl_add_u32 v66, v3, 3, v64
    v_lshlrev_b32 v66, 4, v66
    v_and_b32 v67, 1, v65
    v_lshl_add_u32 v66, v67, 3, v66
    v_lshrrev_b32 v67, 1, v65
    v_mul_u32_u24 v67, 7168, v67
    v_add3_u32 v129, v66, v67, 0
    v_add_u32 v129, 79872, v129
L_tb_done:
    s_lshl_b32 s35, s28, 9
    s_lshl_b32 s36, s33, 7
    s_add_u32 s35, s35, s36
    s_mul_i32 s35, s35, 896
    s_lshl_b32 s36, s34, 7
    s_add_u32 s35, s35, s36
    s_add_u32 s64, s12, s35
    s_addc_u32 s65, s13, 0
    v_lshrrev_b32 v132, 3, v1
    v_mul_u32_u24 v132, 896, v132
    v_add_u32 v132, v132, v62
    s_waitcnt lgkmcnt(0)
    s_barrier
    s_cmp_eq_u32 s30, 0
    s_cbranch_scc1 L_lb_w0
    s_add_u32 s61, s60, 0
    s_min_u32 s61, s61, 15
    s_mul_i32 s62, s61, 7168
    s_add_u32 s44, s64, s62
    s_addc_u32 s45, s65, 0
    s_lshl_b32 s61, s61, 10
    s_add_u32 m0, s61, 94208
    s_nop 0
    global_load_lds_dwordx4 v132, s[44:45] nt
    s_add_u32 s61, s60, 1
    s_min_u32 s61, s61, 15
    s_mul_i32 s62, s61, 7168
    s_add_u32 s44, s64, s62
    s_addc_u32 s45, s65, 0
    s_lshl_b32 s61, s61, 10
    s_add_u32 m0, s61, 94208
    s_nop 0
    global_load_lds_dwordx4 v132, s[44:45] nt
    s_add_u32 s61, s60, 2
    s_min_u32 s61, s61, 15
    s_mul_i32 s62, s61, 7168
    s_add_u32 s44, s64, s62
    s_addc_u32 s45, s65, 0
    s_lshl_b32 s61, s61, 10
    s_add_u32 m0, s61, 94208
    s_nop 0
    global_load_lds_dwordx4 v132, s[44:45] nt
    s_add_u32 s61, s60, 3
    s_min_u32 s61, s61, 15
    s_mul_i32 s62, s61, 7168
    s_add_u32 s44, s64, s62
    s_addc_u32 s45, s65, 0
    s_lshl_b32 s61, s61, 10
    s_add_u32 m0, s61, 94208
    s_nop 0
    global_load_lds_dwordx4 v132, s[44:45] nt
    s_add_u32 s61, s60, 4
    s_min_u32 s61, s61, 15
    s_mul_i32 s62, s61, 7168
    s_add_u32 s44, s64, s62
    s_addc_u32 s45, s65, 0
    s_lshl_b32 s61, s61, 10
    s_add_u32 m0, s61, 94208
    s_nop 0
    global_load_lds_dwordx4 v132, s[44:45] nt
    s_add_u32 s61, s60, 5
    s_min_u32 s61, s61, 15
    s_mul_i32 s62, s61, 7168
    s_add_u32 s44, s64, s62
    s_addc_u32 s45, s65, 0
    s_lshl_b32 s61, s61, 10
    s_add_u32 m0, s61, 94208
    s_nop 0
    global_load_lds_dwordx4 v132, s[44:45] nt
    global_load_dwordx4 a[0:3], v133, s[40:41] offset:0 nt
    global_load_dwordx4 a[4:7], v133, s[40:41] offset:64 nt
    global_load_dwordx4 a[8:11], v133, s[40:41] offset:128 nt
    global_load_dwordx4 a[12:15], v133, s[40:41] offset:192 nt
    s_waitcnt vmcnt(15)
    global_load_dwordx4 a[16:19], v133, s[40:41] offset:256 nt
    s_cmp_lg_u32 s30, 1
    s_cbranch_scc1 L_lb_n1
    v_lshlrev_b32 v18, 16, v75
    v_and_b32 v19, 0xffff0000, v75
    v_mov_b32 v69, 64
    v_mov_b32 v70, 1
    s_mov_b64 exec, 1
    global_atomic_add v69, v70, s[24:25]
    s_mov_b64 exec, -1
L_lb_n1:
    s_waitcnt vmcnt(15)
    global_load_dwordx4 a[20:23], v133, s[40:41] offset:320 nt
    s_waitcnt vmcnt(15)
    global_load_dwordx4 a[24:27], v133, s[40:41] offset:384 nt
    s_waitcnt vmcnt(15)
    global_load_dwordx4 a[28:31], v133, s[40:41] offset:448 nt
    s_waitcnt vmcnt(15)
    global_load_dwordx4 a[32:35], v134, s[40:41] offset:0 nt
    s_waitcnt vmcnt(15)
    global_load_dwordx4 a[36:39], v134, s[40:41] offset:64 nt
    s_waitcnt vmcnt(15)
    global_load_dwordx4 a[40:43], v134, s[40:41] offset:128 nt
    s_waitcnt vmcnt(15)
    global_load_dwordx4 a[44:47], v134, s[40:41] offset:192 nt
    s_waitcnt vmcnt(15)
    global_load_dwordx4 a[48:51], v134, s[40:41] offset:256 nt
    s_waitcnt vmcnt(15)
    global_load_dwordx4 a[52:55], v134, s[40:41] offset:320 nt
    s_waitcnt vmcnt(15)
    global_load_dwordx4 a[56:59], v134, s[40:41] offset:384 nt
    s_waitcnt vmcnt(15)
    global_load_dwordx4 a[60:63], v134, s[40:41] offset:448 nt
    s_waitcnt vmcnt(15)
    s_add_u32 m0, s47, 0
    s_nop 0
    global_load_lds_dwordx4 v135, s[42:43] offset:0 nt
    s_waitcnt vmcnt(15)
    s_add_u32 m0, s47, 3968
    s_nop 0
    global_load_lds_dwordx4 v135, s[42:43] offset:128 nt
    s_waitcnt vmcnt(15)
    s_add_u32 m0, s47, 7936
    s_nop 0
    global_load_lds_dwordx4 v135, s[42:43] offset:256 nt
    s_waitcnt vmcnt(15)
    s_add_u32 m0, s47, 11904
    s_nop 0
    global_load_lds_dwordx4 v135, s[42:43] offset:384 nt
    s_waitcnt vmcnt(15)
    s_add_u32 m0, s47, 1024
    s_nop 0
    global_load_lds_dwordx4 v136, s[42:43] offset:0 nt
    s_waitcnt vmcnt(15)
    s_add_u32 m0, s47, 4992
    s_nop 0
    global_load_lds_dwordx4 v136, s[42:43] offset:128 nt
    s_waitcnt vmcnt(15)
    s_add_u32 m0, s47, 8960
    s_nop 0
    global_load_lds_dwordx4 v136, s[42:43] offset:256 nt
    s_waitcnt vmcnt(15)
    s_add_u32 m0, s47, 12928
    s_nop 0
    global_load_lds_dwordx4 v136, s[42:43] offset:384 nt
    s_waitcnt vmcnt(15)
    s_add_u32 m0, s47, 2048
    s_nop 0
    global_load_lds_dwordx4 v137, s[42:43] offset:0 nt
    s_waitcnt vmcnt(15)
    s_add_u32 m0, s47, 6016
    s_nop 0
    global_load_lds_dwordx4 v137, s[42:43] offset:128 nt
    s_waitcnt vmcnt(15)
    s_add_u32 m0, s47, 9984
    s_nop 0
    global_load_lds_dwordx4 v137, s[42:43] offset:256 nt
    s_waitcnt vmcnt(15)
    s_add_u32 m0, s47, 13952
    s_nop 0
    global_load_lds_dwordx4 v137, s[42:43] offset:384 nt
    s_waitcnt vmcnt(15)
    s_add_u32 m0, s47, 3072
    s_nop 0
    global_load_lds_dwordx4 v138, s[42:43] offset:0 nt
    s_waitcnt vmcnt(15)
    s_add_u32 m0, s47, 7040
    s_nop 0
    global_load_lds_dwordx4 v138, s[42:43] offset:128 nt
    s_waitcnt vmcnt(15)
    s_add_u32 m0, s47, 11008
    s_nop 0
    global_load_lds_dwordx4 v138, s[42:43] offset:256 nt
    s_waitcnt vmcnt(15)
    s_add_u32 m0, s47, 14976
    s_nop 0
    global_load_lds_dwordx4 v138, s[42:43] offset:384 nt
    s_waitcnt vmcnt(16)
    s_branch L_lb_done
L_lb_w0:
L_lb_done:
    s_cmp_lg_u32 s30, 0
    s_cbranch_scc1 Lnotw0_1
    s_waitcnt vmcnt(23)
    ds_read_b64_tr_b16 a[128:129], v129 offset:0
    ds_read_b64_tr_b16 a[130:131], v129 offset:128
    ds_read_b64_tr_b16 a[132:133], v129 offset:1024
    ds_read_b64_tr_b16 a[134:135], v129 offset:1152
    ds_read_b64_tr_b16 a[136:137], v129 offset:2048
    ds_read_b64_tr_b16 a[138:139], v129 offset:2176
    ds_read_b64_tr_b16 a[140:141], v129 offset:3072
    ds_read_b64_tr_b16 a[142:143], v129 offset:3200
    ds_read_b64_tr_b16 a[144:145], v129 offset:4096
    ds_read_b64_tr_b16 a[146:147], v129 offset:4224
    ds_read_b64_tr_b16 a[148:149], v129 offset:5120
    ds_read_b64_tr_b16 a[150:151], v129 offset:5248
    ds_read_b64_tr_b16 a[152:153], v129 offset:6144
    ds_read_b64_tr_b16 a[154:155], v129 offset:6272
    ds_read_b64_tr_b16 a[156:157], v129 offset:7168
    ds_read_b64_tr_b16 a[158:159], v129 offset:7296
    ds_read_b64_tr_b16 a[160:161], v129 offset:8192
    ds_read_b64_tr_b16 a[162:163], v129 offset:8320
    ds_read_b64_tr_b16 a[164:165], v129 offset:9216
    ds_read_b64_tr_b16 a[166:167], v129 offset:9344
    ds_read_b64_tr_b16 a[168:169], v129 offset:10240
    ds_read_b64_tr_b16 a[170:171], v129 offset:10368
    ds_read_b64_tr_b16 a[172:173], v129 offset:11264
    ds_read_b64_tr_b16 a[174:175], v129 offset:11392
    ds_read_b64_tr_b16 a[176:177], v129 offset:12288
    ds_read_b64_tr_b16 a[178:179], v129 offset:12416
    ds_read_b64_tr_b16 a[180:181], v129 offset:13312
    ds_read_b64_tr_b16 a[182:183], v129 offset:13440
    v_and_b32 v141, 31, v1
    v_lshlrev_b32 v141, 2, v141
    global_load_dword v142, v141, s[24:25] offset:128 sc1
    s_waitcnt lgkmcnt(0)
    v_dot2_f32_bf16 v57, v24, v48, 0
    v_dot2_f32_bf16 v58, v24, v24, 0
    v_dot2_f32_bf16 v57, v25, v48, v57
    v_dot2_f32_bf16 v58, v25, v25, v58
    v_dot2_f32_bf16 v57, v26, v48, v57
    v_dot2_f32_bf16 v58, v26, v26, v58
    v_dot2_f32_bf16 v57, v27, v48, v57
    v_dot2_f32_bf16 v58, v27, v27, v58
    v_lshlrev_b32 v100, 16, v24
    v_and_b32 v101, 0xffff0000, v24
    v_cndmask_b32 v57, 0, v57, s[48:49]
    v_cndmask_b32 v58, 0, v58, s[48:49]
    v_lshlrev_b32 v102, 16, v25
    v_add_f32_dpp v57, v57, v57 quad_perm:[1,0,3,2] row_mask:0xf bank_mask:0xf
    v_add_f32_dpp v58, v58, v58 quad_perm:[1,0,3,2] row_mask:0xf bank_mask:0xf
    v_and_b32 v103, 0xffff0000, v25
    v_add_f32_dpp v57, v57, v57 quad_perm:[2,3,0,1] row_mask:0xf bank_mask:0xf
    v_add_f32_dpp v58, v58, v58 quad_perm:[2,3,0,1] row_mask:0xf bank_mask:0xf
    v_lshlrev_b32 v104, 16, v26
    v_add_f32_dpp v57, v57, v57 row_half_mirror row_mask:0xf bank_mask:0xf
    v_add_f32_dpp v58, v58, v58 row_half_mirror row_mask:0xf bank_mask:0xf
    v_and_b32 v105, 0xffff0000, v26
    v_add_f32_dpp v57, v57, v57 row_mirror row_mask:0xf bank_mask:0xf
    v_add_f32_dpp v58, v58, v58 row_mirror row_mask:0xf bank_mask:0xf
    v_lshlrev_b32 v106, 16, v27
    v_and_b32 v107, 0xffff0000, v27
    v_permlane32_swap_b32 v57, v58
    v_add_f32 v57, v57, v58
    v_mov_b32 v58, v57
    v_mov_b32 v56, 0
    s_nop 0
    v_permlane16_swap_b32 v57, v58
    v_add_f32 v57, v57, v58
    s_nop 0
    v_readlane_b32 s50, v57, 0
    v_readlane_b32 s51, v57, 32
    s_nop 0
    v_mul_f32 v60, s50, v21
    v_mul_f32 v61, s51, v21
    v_fma_f32 v61, -v60, v60, v61
    v_max_f32 v61, 0, v61
    v_cvt_pk_bf16_f32 v59, v60, v61
    v_lshlrev_b32 v60, 16, v59
    v_and_b32 v61, 0xffff0000, v59
    v_add_f32 v61, 0x3727c5ac, v61
    v_cvt_pk_bf16_f32 v61, v61, v61
    v_and_b32 v61, 0xffff0000, v61
    v_sqrt_f32 v61, v61
    v_sub_f32 v100, v100, v60
    v_sub_f32 v101, v101, v60
    v_cvt_pk_bf16_f32 v61, v61, v61
    v_sub_f32 v102, v102, v60
    v_and_b32 v61, 0xffff0000, v61
    v_sub_f32 v103, v103, v60
    v_rcp_f32 v61, v61
    v_sub_f32 v104, v104, v60
    v_sub_f32 v105, v105, v60
    v_sub_f32 v106, v106, v60
    v_sub_f32 v107, v107, v60
    v_cvt_pk_bf16_f32 v24, v100, v101
    v_cvt_pk_bf16_f32 v25, v102, v103
    v_cvt_pk_bf16_f32 v26, v104, v105
    v_cvt_pk_bf16_f32 v27, v106, v107
    v_lshlrev_b32 v100, 16, v24
    v_and_b32 v101, 0xffff0000, v24
    v_lshlrev_b32 v102, 16, v25
    v_and_b32 v103, 0xffff0000, v25
    v_lshlrev_b32 v104, 16, v26
    v_and_b32 v105, 0xffff0000, v26
    v_lshlrev_b32 v106, 16, v27
    v_and_b32 v107, 0xffff0000, v27
    v_mul_f32 v100, v100, v61
    v_mul_f32 v101, v101, v61
    v_mul_f32 v102, v102, v61
    v_mul_f32 v103, v103, v61
    v_mul_f32 v104, v104, v61
    v_mul_f32 v105, v105, v61
    v_mul_f32 v106, v106, v61
    v_mul_f32 v107, v107, v61
    v_cvt_pk_bf16_f32 v24, v100, v101
    v_cvt_pk_bf16_f32 v25, v102, v103
    v_cvt_pk_bf16_f32 v26, v104, v105
    v_cvt_pk_bf16_f32 v27, v106, v107
    s_nop 1
    v_mfma_f32_16x16x32_bf16 v[64:67], v[24:27], a[128:131], 0
    v_mfma_f32_16x16x32_bf16 v[68:71], v[24:27], a[132:135], 0
    v_mfma_f32_16x16x32_bf16 v[72:75], v[24:27], a[136:139], 0
    v_mfma_f32_16x16x32_bf16 v[76:79], v[24:27], a[140:143], 0
    v_mfma_f32_16x16x32_bf16 v[80:83], v[24:27], a[144:147], 0
    v_mfma_f32_16x16x32_bf16 v[84:87], v[24:27], a[148:151], 0
    s_nop 2
    v_add_f32_dpp v56, v64, v56 quad_perm:[0,1,2,3] row_mask:0x1 bank_mask:0xf
    v_mfma_f32_16x16x32_bf16 v[88:91], v[24:27], a[152:155], 0
    v_add_f32_dpp v56, v69, v56 quad_perm:[0,1,2,3] row_mask:0x1 bank_mask:0xf
    v_mfma_f32_16x16x32_bf16 v[92:95], v[24:27], a[156:159], 0
    v_add_f32_dpp v56, v74, v56 quad_perm:[0,1,2,3] row_mask:0x1 bank_mask:0xf
    v_mfma_f32_16x16x32_bf16 v[96:99], v[24:27], a[160:163], 0
    v_add_f32_dpp v56, v79, v56 quad_perm:[0,1,2,3] row_mask:0x1 bank_mask:0xf
    v_mfma_f32_16x16x32_bf16 v[156:159], v[24:27], a[164:167], 0
    v_add_f32_dpp v56, v80, v56 quad_perm:[0,1,2,3] row_mask:0x2 bank_mask:0xf
    v_mfma_f32_16x16x32_bf16 v[160:163], v[24:27], a[168:171], 0
    v_add_f32_dpp v56, v85, v56 quad_perm:[0,1,2,3] row_mask:0x2 bank_mask:0xf
    v_mfma_f32_16x16x32_bf16 v[164:167], v[24:27], a[172:175], 0
    v_add_f32_dpp v56, v90, v56 quad_perm:[0,1,2,3] row_mask:0x2 bank_mask:0xf
    v_mfma_f32_16x16x32_bf16 v[168:171], v[24:27], a[176:179], 0
    v_add_f32_dpp v56, v95, v56 quad_perm:[0,1,2,3] row_mask:0x2 bank_mask:0xf
    v_mfma_f32_16x16x32_bf16 v[172:175], v[24:27], a[180:183], 0
    v_add_f32_dpp v56, v96, v56 quad_perm:[0,1,2,3] row_mask:0x4 bank_mask:0xf
    v_add_f32_dpp v56, v157, v56 quad_perm:[0,1,2,3] row_mask:0x4 bank_mask:0xf
    v_add_f32_dpp v56, v162, v56 quad_perm:[0,1,2,3] row_mask:0x4 bank_mask:0xf
    s_nop 0
    v_add_f32_dpp v56, v167, v56 quad_perm:[0,1,2,3] row_mask:0x4 bank_mask:0xf
    s_nop 0
    v_add_f32_dpp v56, v168, v56 quad_perm:[0,1,2,3] row_mask:0x8 bank_mask:0xf
    s_nop 0
    v_add_f32_dpp v56, v173, v56 quad_perm:[0,1,2,3] row_mask:0x8 bank_mask:0xf
    v_mov_b32 v59, v56
    s_nop 1
    v_permlane32_swap_b32 v56, v59
    v_add_f32 v56, v56, v59
    v_mov_b32 v59, v56
    s_nop 1
    v_permlane16_swap_b32 v56, v59
    v_add_f32 v56, v56, v59
    s_nop 1
    v_mov_b32_dpp v143, v56 row_shl:1 row_mask:0xf bank_mask:0xf
    v_cvt_pk_bf16_f32 v143, v56, v143
    v_min_u32 v143, -2, v143
    s_mov_b64 exec, 0x5555
    global_store_dword v12, v143, s[26:27]
    s_mov_b64 exec, -1
    s_or_b32 s79, s31, 0x100
    v_mov_b32 v70, s79
    s_waitcnt vmcnt(18)
    s_mov_b64 exec, 1
    global_store_dword v145, v70, s[24:25] offset:128
    s_mov_b64 exec, -1
    s_mov_b32 s46, 100
    s_waitcnt vmcnt(2)
    s_branch Lchk_7
Lflag_3:
    s_sleep 8
    global_load_dword v142, v141, s[24:25] offset:128 sc1
    s_sub_u32 s46, s46, 1
    s_cbranch_scc1 Limp_4
    s_waitcnt vmcnt(0)
Lchk_7:
    v_and_b32 v63, 0xff, v142
    v_cmp_ne_u32 vcc, s31, v63
    s_cbranch_vccnz Lflag_3
    s_mov_b32 s32, 1
    s_mov_b32 s46, 65536
    s_branch Lq2b_9
Lq2_8:
    s_sleep 8
Lq2b_9:
    global_load_dwordx4 v[24:27], v4, s[26:27] sc1
    global_load_dword v142, v141, s[24:25] offset:128 sc1
    s_sub_u32 s46, s46, 1
    s_cbranch_scc1 L_bail
    s_waitcnt vmcnt(0)
    v_max3_u32 v63, v24, v25, v26
    v_max_u32 v63, v63, v27
    v_cmp_eq_u32 vcc, -1, v63
    s_cbranch_vccnz Lq2_8
    v_cmp_ne_u32 vcc, s79, v142
    s_cbranch_vccnz Lq2_8
    s_branch Lq3_10
Lflaggo_6:
    s_mov_b32 s46, 65536
Lpoll_11:
    global_load_dwordx4 v[24:27], v4, s[26:27] offset:0 sc1
    s_sub_u32 s46, s46, 1
    s_cbranch_scc1 L_bail
    s_waitcnt vmcnt(0)
    v_max3_u32 v63, v24, v25, v26
    v_max_u32 v63, v63, v27
    v_cmp_eq_u32 vcc, -1, v63
    s_cbranch_vccnz Lpoll_11
Lq3_10:
    v_mov_b32 v66, s32
    v_mov_b32 v67, 134208
    ds_write_b32 v67, v66
    ds_write_b128 v22, v[24:27]
    s_waitcnt lgkmcnt(0)
Lnotw0_1:
    s_barrier
    v_mov_b32 v62, 134208
    ds_read_b32 v61, v62
    ds_read_b128 v[64:67], v146 offset:0
    ds_read_b128 v[68:71], v146 offset:32
    ds_read_b128 v[72:75], v146 offset:64
    ds_read_b128 v[76:79], v146 offset:96
    ds_read_b128 v[80:83], v146 offset:128
    ds_read_b128 v[84:87], v146 offset:160
    ds_read_b128 v[88:91], v146 offset:192
    ds_read_b128 v[92:95], v146 offset:224
    s_waitcnt lgkmcnt(7)
    v_readfirstlane_b32 s32, v61
    v_mfma_f32_16x16x32_bf16 v[36:39], a[0:3], v[64:67], 0
    v_mfma_f32_16x16x32_bf16 v[40:43], a[32:35], v[64:67], 0
    s_waitcnt lgkmcnt(6)
    v_mfma_f32_16x16x32_bf16 v[36:39], a[4:7], v[68:71], v[36:39]
    v_mfma_f32_16x16x32_bf16 v[40:43], a[36:39], v[68:71], v[40:43]
    s_waitcnt lgkmcnt(5)
    v_mfma_f32_16x16x32_bf16 v[36:39], a[8:11], v[72:75], v[36:39]
    v_mfma_f32_16x16x32_bf16 v[40:43], a[40:43], v[72:75], v[40:43]
    s_waitcnt lgkmcnt(4)
    v_mfma_f32_16x16x32_bf16 v[36:39], a[12:15], v[76:79], v[36:39]
    v_mfma_f32_16x16x32_bf16 v[40:43], a[44:47], v[76:79], v[40:43]
    s_waitcnt lgkmcnt(3)
    v_mfma_f32_16x16x32_bf16 v[36:39], a[16:19], v[80:83], v[36:39]
    v_mfma_f32_16x16x32_bf16 v[40:43], a[48:51], v[80:83], v[40:43]
    s_waitcnt lgkmcnt(2)
    v_mfma_f32_16x16x32_bf16 v[36:39], a[20:23], v[84:87], v[36:39]
    v_mfma_f32_16x16x32_bf16 v[40:43], a[52:55], v[84:87], v[40:43]
    s_waitcnt lgkmcnt(1)
    v_mfma_f32_16x16x32_bf16 v[36:39], a[24:27], v[88:91], v[36:39]
    v_mfma_f32_16x16x32_bf16 v[40:43], a[56:59], v[88:91], v[40:43]
    s_waitcnt lgkmcnt(0)
    v_mfma_f32_16x16x32_bf16 v[36:39], a[28:31], v[92:95], v[36:39]
    v_mfma_f32_16x16x32_bf16 v[40:43], a[60:63], v[92:95], v[40:43]
    s_nop 6
    v_cvt_pk_bf16_f32 v28, v36, v37
    v_cvt_pk_bf16_f32 v29, v38, v39
    v_cvt_pk_bf16_f32 v30, v40, v41
    v_cvt_pk_bf16_f32 v31, v42, v43
    v_lshlrev_b32 v36, 16, v28
    v_and_b32 v37, 0xffff0000, v28
    v_lshlrev_b32 v38, 16, v29
    v_and_b32 v39, 0xffff0000, v29
    v_lshlrev_b32 v40, 16, v30
    v_and_b32 v41, 0xffff0000, v30
    v_lshlrev_b32 v42, 16, v31
    v_and_b32 v43, 0xffff0000, v31
    v_max3_f32 v56, v36, v37, v38
    v_max3_f32 v57, v39, v40, v41
    v_max3_f32 v56, v56, v42, v43
    v_max_f32 v56, v56, v57
    v_mov_b32 v57, v56
    s_nop 1
    v_permlane32_swap_b32 v56, v57
    v_max_f32 v56, v56, v57
    v_mov_b32 v57, v56
    s_nop 1
    v_permlane16_swap_b32 v56, v57
    v_max_f32 v56, v56, v57
    s_mov_b64 exec, 0x3
    ds_write_b32 v16, v56
    s_mov_b64 exec, -1
    s_waitcnt lgkmcnt(0)
    s_barrier
    ds_read_b128 v[64:67], v144
    s_mov_b32 s56, 0x00030003
    s_mov_b32 s57, 0x00030003
    s_waitcnt lgkmcnt(0)
    v_max3_f32 v56, v64, v65, v66
    v_max_f32 v56, v56, v67
    v_mul_f32 v58, s52, v56
    v_fma_f32 v36, v36, s52, -v58
    v_fma_f32 v37, v37, s52, -v58
    v_fma_f32 v38, v38, s52, -v58
    v_fma_f32 v39, v39, s52, -v58
    v_fma_f32 v40, v40, s52, -v58
    v_fma_f32 v41, v41, s52, -v58
    v_fma_f32 v42, v42, s52, -v58
    v_fma_f32 v43, v43, s52, -v58
    v_exp_f32 v36, v36
    v_exp_f32 v37, v37
    v_exp_f32 v38, v38
    v_exp_f32 v39, v39
    v_exp_f32 v40, v40
    v_exp_f32 v41, v41
    v_exp_f32 v42, v42
    v_exp_f32 v43, v43
    v_cvt_pk_bf16_f32 v44, v36, v37
    v_cvt_pk_bf16_f32 v45, v38, v39
    v_cvt_pk_bf16_f32 v46, v40, v41
    v_cvt_pk_bf16_f32 v47, v42, v43
    s_mov_b64 exec, s[56:57]
    ds_write_b128 v14, v[44:47]
    s_mov_b64 exec, -1
    s_cmp_eq_u32 s30, 0
    s_cbranch_scc1 Lskip_13
    s_waitcnt vmcnt(0)
Lskip_13:
    s_cmp_ge_u32 s30, 2
    s_cbranch_scc1 Lwarm_14
    global_load_dwordx4 v[176:179], v7, s[26:27] offset:0 sc1
    global_load_dwordx4 v[180:183], v8, s[26:27] offset:0 sc1
    global_load_dwordx2 v[192:193], v9, s[26:27] offset:0 sc1
Lwarm_14:
    s_waitcnt lgkmcnt(0)
    s_barrier
    ds_read_b128 v[96:99], v15 offset:0
    ds_read_b128 v[100:103], v15 offset:128
    ds_read_b128 v[104:107], v15 offset:256
    ds_read_b128 v[108:111], v15 offset:384
    ds_read_b64_tr_b16 a[64:65], v17 offset:0
    ds_read_b64_tr_b16 a[66:67], v17 offset:2048
    ds_read_b64_tr_b16 a[68:69], v17 offset:8
    ds_read_b64_tr_b16 a[70:71], v17 offset:2056
    ds_read_b64_tr_b16 a[72:73], v17 offset:64
    ds_read_b64_tr_b16 a[74:75], v17 offset:2112
    ds_read_b64_tr_b16 a[76:77], v17 offset:72
    ds_read_b64_tr_b16 a[78:79], v17 offset:2120
    ds_read_b64_tr_b16 a[80:81], v17 offset:16384
    ds_read_b64_tr_b16 a[82:83], v17 offset:18432
    ds_read_b64_tr_b16 a[84:85], v17 offset:16392
    ds_read_b64_tr_b16 a[86:87], v17 offset:18440
    ds_read_b64_tr_b16 a[88:89], v17 offset:16448
    ds_read_b64_tr_b16 a[90:91], v17 offset:18496
    ds_read_b64_tr_b16 a[92:93], v17 offset:16456
    ds_read_b64_tr_b16 a[94:95], v17 offset:18504
    ds_read_b64_tr_b16 a[96:97], v17 offset:32768
    ds_read_b64_tr_b16 a[98:99], v17 offset:34816
    ds_read_b64_tr_b16 a[100:101], v17 offset:32776
    ds_read_b64_tr_b16 a[102:103], v17 offset:34824
    ds_read_b64_tr_b16 a[104:105], v17 offset:32832
    ds_read_b64_tr_b16 a[106:107], v17 offset:34880
    ds_read_b64_tr_b16 a[108:109], v17 offset:32840
    ds_read_b64_tr_b16 a[110:111], v17 offset:34888
    ds_read_b64_tr_b16 a[112:113], v17 offset:49152
    ds_read_b64_tr_b16 a[114:115], v17 offset:51200
    ds_read_b64_tr_b16 a[116:117], v17 offset:49160
    ds_read_b64_tr_b16 a[118:119], v17 offset:51208
    ds_read_b64_tr_b16 a[120:121], v17 offset:49216
    ds_read_b64_tr_b16 a[122:123], v17 offset:51264
    ds_read_b64_tr_b16 a[124:125], v17 offset:49224
    ds_read_b64_tr_b16 a[126:127], v17 offset:51272
    s_cmp_lg_u32 s30, 3
    s_cbranch_scc1 Lnol_15
    s_waitcnt lgkmcnt(15)
    v_mfma_f32_16x16x32_bf16 v[52:55], v[48:51], v[96:99], 0
    v_mfma_f32_16x16x32_bf16 v[52:55], v[48:51], v[100:103], v[52:55]
    v_mfma_f32_16x16x32_bf16 v[52:55], v[48:51], v[104:107], v[52:55]
    v_mfma_f32_16x16x32_bf16 v[52:55], v[48:51], v[108:111], v[52:55]
Lnol_15:
    s_waitcnt lgkmcnt(15)
    v_mfma_f32_16x16x32_bf16 v[64:67], a[64:67], v[96:99], 0
    v_mfma_f32_16x16x32_bf16 v[68:71], a[68:71], v[96:99], 0
    v_mfma_f32_16x16x32_bf16 v[72:75], a[72:75], v[96:99], 0
    v_mfma_f32_16x16x32_bf16 v[76:79], a[76:79], v[96:99], 0
    s_waitcnt lgkmcnt(15)
    v_mfma_f32_16x16x32_bf16 v[64:67], a[80:83], v[100:103], v[64:67]
    v_mfma_f32_16x16x32_bf16 v[68:71], a[84:87], v[100:103], v[68:71]
    v_mfma_f32_16x16x32_bf16 v[72:75], a[88:91], v[100:103], v[72:75]
    v_mfma_f32_16x16x32_bf16 v[76:79], a[92:95], v[100:103], v[76:79]
    s_waitcnt lgkmcnt(8)
    v_mfma_f32_16x16x32_bf16 v[64:67], a[96:99], v[104:107], v[64:67]
    v_mfma_f32_16x16x32_bf16 v[68:71], a[100:103], v[104:107], v[68:71]
    v_mfma_f32_16x16x32_bf16 v[72:75], a[104:107], v[104:107], v[72:75]
    v_mfma_f32_16x16x32_bf16 v[76:79], a[108:111], v[104:107], v[76:79]
    s_waitcnt lgkmcnt(0)
    v_mfma_f32_16x16x32_bf16 v[64:67], a[112:115], v[108:111], v[64:67]
    v_mfma_f32_16x16x32_bf16 v[68:71], a[116:119], v[108:111], v[68:71]
    v_mfma_f32_16x16x32_bf16 v[72:75], a[120:123], v[108:111], v[72:75]
    v_mfma_f32_16x16x32_bf16 v[76:79], a[124:127], v[108:111], v[76:79]
    s_nop 4
    v_cvt_pk_bf16_f32 v80, v64, v65
    v_cvt_pk_bf16_f32 v81, v66, v67
    v_cvt_pk_bf16_f32 v82, v68, v69
    v_cvt_pk_bf16_f32 v83, v70, v71
    v_min_u32 v80, -2, v80
    v_min_u32 v81, -2, v81
    v_min_u32 v82, -2, v82
    v_min_u32 v83, -2, v83
    v_cvt_pk_bf16_f32 v84, v72, v73
    v_cvt_pk_bf16_f32 v85, v74, v75
    v_cvt_pk_bf16_f32 v86, v76, v77
    v_cvt_pk_bf16_f32 v87, v78, v79
    v_min_u32 v84, -2, v84
    v_min_u32 v85, -2, v85
    v_min_u32 v86, -2, v86
    v_min_u32 v87, -2, v87
    s_mov_b64 exec, s[56:57]
    s_cmp_lg_u32 s32, 0
    s_cbranch_scc0 Lslow_16
    global_store_dwordx4 v5, v[80:83], s[26:27] offset:0
    global_store_dwordx4 v5, v[84:87], s[26:27] offset:64
    s_nop 1
Lback_17:
    s_cmp_lg_u32 s30, 3
    s_cbranch_scc1 Lnost_18
    v_min_u32 v58, -2, v58
    v_min_u32 v59, -2, v52
    s_mov_b64 exec, 0x3
    s_cmp_lg_u32 s32, 0
    s_cbranch_scc0 Lslow_19
    global_store_dwordx2 v6, v[58:59], s[26:27] offset:0
Lback_20:
Lnost_18:
    s_mov_b64 exec, -1
    s_cmp_lt_u32 s30, 2
    s_cbranch_scc1 Lfld_22
    v_and_b32 v64, 31, v1
    v_min_u32 v64, 27, v64
    v_lshlrev_b32 v64, 4, v64
    v_lshrrev_b32 v65, 5, v1
    v_mul_u32_u24 v65, 3584, v65
    v_add_u32 v64, v64, v65
    s_mul_i32 s35, s29, 50176
    s_mul_i32 s36, s28, 448
    s_add_u32 s35, s35, s36
    s_cmp_eq_u32 s30, 2
    s_cselect_b32 s44, s16, s18
    s_cselect_b32 s45, s17, s19
    s_add_u32 s44, s44, s35
    s_addc_u32 s45, s45, 0
    global_load_dwordx4 v[68:71], v64, s[44:45]
    s_add_u32 s44, s44, 7168
    s_addc_u32 s45, s45, 0
    global_load_dwordx4 v[68:71], v64, s[44:45]
    s_add_u32 s44, s44, 7168
    s_addc_u32 s45, s45, 0
    global_load_dwordx4 v[68:71], v64, s[44:45]
    s_add_u32 s44, s44, 7168
    s_addc_u32 s45, s45, 0
    global_load_dwordx4 v[68:71], v64, s[44:45]
    s_add_u32 s44, s44, 7168
    s_addc_u32 s45, s45, 0
    global_load_dwordx4 v[68:71], v64, s[44:45]
    s_add_u32 s44, s44, 7168
    s_addc_u32 s45, s45, 0
    global_load_dwordx4 v[68:71], v64, s[44:45]
    s_add_u32 s44, s44, 7168
    s_addc_u32 s45, s45, 0
    global_load_dwordx4 v[68:71], v64, s[44:45]
    v_lshlrev_b32 v64, 4, v1
    s_mul_i32 s35, s28, 200704
    s_mul_i32 s36, s29, 6272
    s_add_u32 s35, s35, s36
    s_sub_u32 s36, s30, 2
    s_mul_i32 s36, s36, 3136
    s_add_u32 s35, s35, s36
    s_add_u32 s44, s20, s35
    s_addc_u32 s45, s21, 0
    global_load_dwordx4 v[68:71], v64, s[44:45] offset:0
    global_load_dwordx4 v[68:71], v64, s[44:45] offset:1024
    global_load_dwordx4 v[68:71], v64, s[44:45] offset:2048
    v_min_u32 v64, 48, v64
    global_load_dwordx4 v[68:71], v64, s[44:45] offset:3072
    s_waitcnt vmcnt(0)
    s_sleep 10
    s_cmp_eq_u32 s30, 3
    s_cbranch_scc1 Lfl3_21
    s_cmp_ge_u32 s29, 14
    s_cbranch_scc1 Lfld_22
    s_mul_i32 s35, s28, 200704
    s_lshl_b32 s36, s29, 6
    s_add_u32 s35, s35, s36
    s_add_u32 s44, s20, s35
    s_addc_u32 s45, s21, 0
    v_lshrrev_b32 v64, 2, v1
    v_mul_u32_u24 v64, 896, v64
    v_and_b32 v65, 3, v1
    v_lshl_add_u32 v64, v65, 4, v64
    s_mov_b32 m0, 110592
    s_nop 0
    global_load_lds_dwordx4 v64, s[44:45]
    s_add_u32 s44, s44, 14336
    s_addc_u32 s45, s45, 0
    s_mov_b32 m0, 111616
    s_nop 0
    global_load_lds_dwordx4 v64, s[44:45]
    s_add_u32 s44, s44, 14336
    s_addc_u32 s45, s45, 0
    s_mov_b32 m0, 112640
    s_nop 0
    global_load_lds_dwordx4 v64, s[44:45]
    s_add_u32 s44, s44, 14336
    s_addc_u32 s45, s45, 0
    s_mov_b32 m0, 113664
    s_nop 0
    global_load_lds_dwordx4 v64, s[44:45]
    s_add_u32 s44, s44, 14336
    s_addc_u32 s45, s45, 0
    s_waitcnt vmcnt(3)
    s_mov_b32 m0, 114688
    s_nop 0
    global_load_lds_dwordx4 v64, s[44:45]
    s_add_u32 s44, s44, 14336
    s_addc_u32 s45, s45, 0
    s_waitcnt vmcnt(3)
    s_mov_b32 m0, 115712
    s_nop 0
    global_load_lds_dwordx4 v64, s[44:45]
    s_add_u32 s44, s44, 14336
    s_addc_u32 s45, s45, 0
    s_waitcnt vmcnt(3)
    s_mov_b32 m0, 116736
    s_nop 0
    global_load_lds_dwordx4 v64, s[44:45]
    s_add_u32 s44, s44, 14336
    s_addc_u32 s45, s45, 0
    s_waitcnt vmcnt(3)
    s_mov_b32 m0, 117760
    s_nop 0
    global_load_lds_dwordx4 v64, s[44:45]
    s_add_u32 s44, s44, 14336
    s_addc_u32 s45, s45, 0
    s_waitcnt vmcnt(3)
    s_mov_b32 m0, 118784
    s_nop 0
    global_load_lds_dwordx4 v64, s[44:45]
    s_add_u32 s44, s44, 14336
    s_addc_u32 s45, s45, 0
    s_waitcnt vmcnt(3)
    s_mov_b32 m0, 119808
    s_nop 0
    global_load_lds_dwordx4 v64, s[44:45]
    s_add_u32 s44, s44, 14336
    s_addc_u32 s45, s45, 0
    s_waitcnt vmcnt(3)
    s_mov_b32 m0, 120832
    s_nop 0
    global_load_lds_dwordx4 v64, s[44:45]
    s_add_u32 s44, s44, 14336
    s_addc_u32 s45, s45, 0
    s_waitcnt vmcnt(3)
    s_mov_b32 m0, 121856
    s_nop 0
    global_load_lds_dwordx4 v64, s[44:45]
    s_add_u32 s44, s44, 14336
    s_addc_u32 s45, s45, 0
    s_waitcnt vmcnt(3)
    s_mov_b32 m0, 122880
    s_nop 0
    global_load_lds_dwordx4 v64, s[44:45]
    s_add_u32 s44, s44, 14336
    s_addc_u32 s45, s45, 0
    s_waitcnt vmcnt(3)
    s_mov_b32 m0, 123904
    s_nop 0
    global_load_lds_dwordx4 v64, s[44:45]
    s_branch Lfld_22
Lfl3_21:
    s_cmp_ge_u32 s29, 28
    s_cbranch_scc1 Lfld_22
    s_mul_i32 s35, s28, 448
    s_lshl_b32 s36, s29, 4
    s_add_u32 s35, s35, s36
    s_add_u32 s44, s16, s35
    s_addc_u32 s45, s17, 0
    v_mul_u32_u24 v64, 3584, v1
    s_mov_b32 m0, 79872
    s_nop 0
    global_load_lds_dwordx4 v64, s[44:45]
    s_add_u32 s44, s44, 229376
    s_addc_u32 s45, s45, 0
    s_mov_b32 m0, 80896
    s_nop 0
    global_load_lds_dwordx4 v64, s[44:45]
    s_add_u32 s44, s44, 229376
    s_addc_u32 s45, s45, 0
    s_mov_b32 m0, 81920
    s_nop 0
    global_load_lds_dwordx4 v64, s[44:45]
    s_add_u32 s44, s44, 229376
    s_addc_u32 s45, s45, 0
    s_mov_b32 m0, 82944
    s_nop 0
    global_load_lds_dwordx4 v64, s[44:45]
    s_add_u32 s44, s44, 229376
    s_addc_u32 s45, s45, 0
    s_waitcnt vmcnt(3)
    s_mov_b32 m0, 83968
    s_nop 0
    global_load_lds_dwordx4 v64, s[44:45]
    s_add_u32 s44, s44, 229376
    s_addc_u32 s45, s45, 0
    s_waitcnt vmcnt(3)
    s_mov_b32 m0, 84992
    s_nop 0
    global_load_lds_dwordx4 v64, s[44:45]
    s_add_u32 s44, s44, 229376
    s_addc_u32 s45, s45, 0
    s_waitcnt vmcnt(3)
    s_mov_b32 m0, 86016
    s_nop 0
    global_load_lds_dwordx4 v64, s[44:45]
    s_add_u32 s44, s18, s35
    s_addc_u32 s45, s19, 0
    s_waitcnt vmcnt(3)
    s_mov_b32 m0, 87040
    s_nop 0
    global_load_lds_dwordx4 v64, s[44:45]
    s_add_u32 s44, s44, 229376
    s_addc_u32 s45, s45, 0
    s_waitcnt vmcnt(3)
    s_mov_b32 m0, 88064
    s_nop 0
    global_load_lds_dwordx4 v64, s[44:45]
    s_add_u32 s44, s44, 229376
    s_addc_u32 s45, s45, 0
    s_waitcnt vmcnt(3)
    s_mov_b32 m0, 89088
    s_nop 0
    global_load_lds_dwordx4 v64, s[44:45]
    s_add_u32 s44, s44, 229376
    s_addc_u32 s45, s45, 0
    s_waitcnt vmcnt(3)
    s_mov_b32 m0, 90112
    s_nop 0
    global_load_lds_dwordx4 v64, s[44:45]
    s_add_u32 s44, s44, 229376
    s_addc_u32 s45, s45, 0
    s_waitcnt vmcnt(3)
    s_mov_b32 m0, 91136
    s_nop 0
    global_load_lds_dwordx4 v64, s[44:45]
    s_add_u32 s44, s44, 229376
    s_addc_u32 s45, s45, 0
    s_waitcnt vmcnt(3)
    s_mov_b32 m0, 92160
    s_nop 0
    global_load_lds_dwordx4 v64, s[44:45]
    s_add_u32 s44, s44, 229376
    s_addc_u32 s45, s45, 0
    s_waitcnt vmcnt(3)
    s_mov_b32 m0, 93184
    s_nop 0
    global_load_lds_dwordx4 v64, s[44:45]
Lfld_22:
    s_cmp_ge_u32 s29, 28
    s_cbranch_scc1 Lnop3_24
    s_cmp_ge_u32 s30, 2
    s_cbranch_scc1 Lp3bar_25
    ds_read_b64_tr_b16 a[184:185], v128 offset:0
    ds_read_b64_tr_b16 a[186:187], v128 offset:512
    ds_read_b64_tr_b16 a[188:189], v128 offset:32
    ds_read_b64_tr_b16 a[190:191], v128 offset:544
    ds_read_b64_tr_b16 a[192:193], v128 offset:64
    ds_read_b64_tr_b16 a[194:195], v128 offset:576
    ds_read_b64_tr_b16 a[196:197], v128 offset:96
    ds_read_b64_tr_b16 a[198:199], v128 offset:608
    ds_read_b64_tr_b16 a[200:201], v128 offset:4096
    ds_read_b64_tr_b16 a[202:203], v128 offset:4608
    ds_read_b64_tr_b16 a[204:205], v128 offset:4128
    ds_read_b64_tr_b16 a[206:207], v128 offset:4640
    ds_read_b64_tr_b16 a[208:209], v128 offset:4160
    ds_read_b64_tr_b16 a[210:211], v128 offset:4672
    ds_read_b64_tr_b16 a[212:213], v128 offset:4192
    ds_read_b64_tr_b16 a[214:215], v128 offset:4704
    s_waitcnt lgkmcnt(0)
    s_mov_b32 s46, 65536
Lpoll_26:
    global_load_dwordx4 v[156:159], v7, s[26:27] offset:0 sc1
    global_load_dwordx4 v[160:163], v8, s[26:27] offset:0 sc1
    global_load_dwordx4 v[164:167], v7, s[26:27] offset:64 sc1
    global_load_dwordx4 v[168:171], v8, s[26:27] offset:64 sc1
    global_load_dwordx2 v[172:173], v9, s[26:27] offset:0 sc1
    s_sub_u32 s46, s46, 1
    s_cbranch_scc1 L_bail
    s_waitcnt vmcnt(0)
    v_max3_u32 v63, v156, v157, v158
    v_max3_u32 v63, v63, v159, v160
    v_max3_u32 v63, v63, v161, v162
    v_max3_u32 v63, v63, v163, v164
    v_max3_u32 v63, v63, v165, v166
    v_max3_u32 v63, v63, v167, v168
    v_max3_u32 v63, v63, v169, v170
    v_max3_u32 v63, v63, v171, v172
    v_max_u32 v63, v63, v173
    v_cmp_eq_u32 vcc, -1, v63
    s_cbranch_vccnz Lpoll_26
    v_mov_b32 v32, v172
    v_mov_b32 v33, v173
    v_mfma_f32_16x16x32_bf16 v[64:67], v[156:159], a[184:187], 0
    v_mfma_f32_16x16x32_bf16 v[68:71], v[160:163], a[184:187], 0
    v_mfma_f32_16x16x32_bf16 v[72:75], v[156:159], a[188:191], 0
    v_mfma_f32_16x16x32_bf16 v[76:79], v[160:163], a[188:191], 0
    v_mfma_f32_16x16x32_bf16 v[80:83], v[156:159], a[192:195], 0
    v_mfma_f32_16x16x32_bf16 v[84:87], v[160:163], a[192:195], 0
    v_mfma_f32_16x16x32_bf16 v[88:91], v[156:159], a[196:199], 0
    v_mfma_f32_16x16x32_bf16 v[92:95], v[160:163], a[196:199], 0
    v_mfma_f32_16x16x32_bf16 v[64:67], v[164:167], a[200:203], v[64:67]
    v_mfma_f32_16x16x32_bf16 v[68:71], v[168:171], a[200:203], v[68:71]
    v_mfma_f32_16x16x32_bf16 v[72:75], v[164:167], a[204:207], v[72:75]
    v_mfma_f32_16x16x32_bf16 v[76:79], v[168:171], a[204:207], v[76:79]
    v_mfma_f32_16x16x32_bf16 v[80:83], v[164:167], a[208:211], v[80:83]
    v_mfma_f32_16x16x32_bf16 v[84:87], v[168:171], a[208:211], v[84:87]
    v_mfma_f32_16x16x32_bf16 v[88:91], v[164:167], a[212:215], v[88:91]
    v_mfma_f32_16x16x32_bf16 v[92:95], v[168:171], a[212:215], v[92:95]
    v_mov_b32 v56, v32
    s_nop 1
    v_max_f32_dpp v56, v56, v56 quad_perm:[1,0,3,2] row_mask:0xf bank_mask:0xf
    s_nop 1
    v_max_f32_dpp v56, v56, v56 quad_perm:[2,3,0,1] row_mask:0xf bank_mask:0xf
    s_nop 1
    v_max_f32_dpp v56, v56, v56 row_half_mirror row_mask:0xf bank_mask:0xf
    v_mov_b32 v57, v56
    s_nop 1
    v_permlane32_swap_b32 v56, v57
    v_max_f32 v56, v56, v57
    v_mov_b32 v57, v56
    s_nop 1
    v_permlane16_swap_b32 v56, v57
    v_max_f32 v56, v56, v57
    v_sub_f32 v58, v32, v56
    v_exp_f32 v58, v58
    s_nop 1
    v_mul_f32_dpp v100, v58, v64 row_newbcast:0 row_mask:0xf bank_mask:0xf
    v_mul_f32_dpp v101, v58, v72 row_newbcast:0 row_mask:0xf bank_mask:0xf
    v_mul_f32 v59, v58, v33
    v_mul_f32_dpp v102, v58, v80 row_newbcast:0 row_mask:0xf bank_mask:0xf
    v_mul_f32_dpp v103, v58, v88 row_newbcast:0 row_mask:0xf bank_mask:0xf
    v_add_f32_dpp v59, v59, v59 quad_perm:[1,0,3,2] row_mask:0xf bank_mask:0xf
    v_fmac_f32_dpp v100, v58, v65 row_newbcast:1 row_mask:0xf bank_mask:0xf
    v_fmac_f32_dpp v101, v58, v73 row_newbcast:1 row_mask:0xf bank_mask:0xf
    v_add_f32_dpp v59, v59, v59 quad_perm:[2,3,0,1] row_mask:0xf bank_mask:0xf
    v_fmac_f32_dpp v102, v58, v81 row_newbcast:1 row_mask:0xf bank_mask:0xf
    v_fmac_f32_dpp v103, v58, v89 row_newbcast:1 row_mask:0xf bank_mask:0xf
    v_add_f32_dpp v59, v59, v59 row_half_mirror row_mask:0xf bank_mask:0xf
    v_fmac_f32_dpp v100, v58, v66 row_newbcast:2 row_mask:0xf bank_mask:0xf
    v_fmac_f32_dpp v101, v58, v74 row_newbcast:2 row_mask:0xf bank_mask:0xf
    v_mov_b32 v57, v59
    v_fmac_f32_dpp v102, v58, v82 row_newbcast:2 row_mask:0xf bank_mask:0xf
    v_fmac_f32_dpp v103, v58, v90 row_newbcast:2 row_mask:0xf bank_mask:0xf
    v_permlane32_swap_b32 v59, v57
    v_fmac_f32_dpp v100, v58, v67 row_newbcast:3 row_mask:0xf bank_mask:0xf
    v_fmac_f32_dpp v101, v58, v75 row_newbcast:3 row_mask:0xf bank_mask:0xf
    v_add_f32 v59, v59, v57
    v_fmac_f32_dpp v102, v58, v83 row_newbcast:3 row_mask:0xf bank_mask:0xf
    v_fmac_f32_dpp v103, v58, v91 row_newbcast:3 row_mask:0xf bank_mask:0xf
    v_mov_b32 v57, v59
    v_fmac_f32_dpp v100, v58, v68 row_newbcast:4 row_mask:0xf bank_mask:0xf
    v_fmac_f32_dpp v101, v58, v76 row_newbcast:4 row_mask:0xf bank_mask:0xf
    v_permlane16_swap_b32 v59, v57
    v_fmac_f32_dpp v102, v58, v84 row_newbcast:4 row_mask:0xf bank_mask:0xf
    v_fmac_f32_dpp v103, v58, v92 row_newbcast:4 row_mask:0xf bank_mask:0xf
    v_add_f32 v59, v59, v57
    v_fmac_f32_dpp v100, v58, v69 row_newbcast:5 row_mask:0xf bank_mask:0xf
    v_fmac_f32_dpp v101, v58, v77 row_newbcast:5 row_mask:0xf bank_mask:0xf
    v_rcp_f32 v59, v59
    v_fmac_f32_dpp v102, v58, v85 row_newbcast:5 row_mask:0xf bank_mask:0xf
    v_fmac_f32_dpp v103, v58, v93 row_newbcast:5 row_mask:0xf bank_mask:0xf
    v_fmac_f32_dpp v100, v58, v70 row_newbcast:6 row_mask:0xf bank_mask:0xf
    v_fmac_f32_dpp v101, v58, v78 row_newbcast:6 row_mask:0xf bank_mask:0xf
    v_fmac_f32_dpp v102, v58, v86 row_newbcast:6 row_mask:0xf bank_mask:0xf
    v_fmac_f32_dpp v103, v58, v94 row_newbcast:6 row_mask:0xf bank_mask:0xf
    v_fmac_f32_dpp v100, v58, v71 row_newbcast:7 row_mask:0xf bank_mask:0xf
    v_fmac_f32_dpp v101, v58, v79 row_newbcast:7 row_mask:0xf bank_mask:0xf
    v_fmac_f32_dpp v102, v58, v87 row_newbcast:7 row_mask:0xf bank_mask:0xf
    v_fmac_f32_dpp v103, v58, v95 row_newbcast:7 row_mask:0xf bank_mask:0xf
    s_nop 0
    v_permlane32_swap_b32 v100, v102
    v_permlane32_swap_b32 v101, v103
    v_add_f32 v100, v100, v102
    v_add_f32 v101, v101, v103
    s_nop 1
    v_permlane16_swap_b32 v100, v101
    v_add_f32 v100, v100, v101
    v_mul_f32 v100, v100, v59
    s_mov_b32 s46, 4194304
    s_cmp_lg_u32 s30, 0
    s_cbranch_scc0 Lspin_29
    v_min_u32 v100, -2, v100
    ds_write_b32 v23, v100 offset:0
    s_branch Lnotw0c_28
Lspin_29:
    ds_read_b32 v101, v23 offset:0
    s_sub_u32 s46, s46, 1
    s_cbranch_scc1 L_bail
    s_waitcnt lgkmcnt(0)
    v_cmp_eq_u32 vcc, -1, v101
    s_cbranch_vccnz Lspin_29
    v_add_f32 v100, v100, v101
    v_min_u32 v100, -2, v100
    global_store_dword v10, v100, s[26:27] offset:-2048 sc1
Lnotw0c_28:
Lp3bar_25:
Lnop3_24:
    s_cmp_eq_u32 s30, 1
    s_cbranch_scc1 Lr1_30
    s_cmp_eq_u32 s30, 2
    s_cbranch_scc1 Lr2_31
    s_cmp_eq_u32 s30, 3
    s_cbranch_scc1 Lr3_32
    s_branch Lrd_33
Lr1_30:
    s_cmp_ge_u32 s29, 14
    s_cbranch_scc1 Lrd_33
    v_mov_b32 v64, 64
    s_mov_b32 s46, 65536
Lc1_34:
    global_load_dword v65, v64, s[24:25] sc1
    s_sub_u32 s46, s46, 1
    s_cbranch_scc1 L_bail
    s_waitcnt vmcnt(0)
    v_cmp_gt_u32 vcc, 0x100, v65
    s_cbranch_vccnz Lc1_34
    s_sleep 16
    s_mov_b32 s46, 65536
Lpoll_35:
    global_load_dwordx4 v[176:179], v11, s[26:27] offset:-4096 sc1
    global_load_dwordx4 v[180:183], v11, s[26:27] offset:-3072 sc1
    global_load_dwordx4 v[184:187], v11, s[26:27] offset:-2048 sc1
    global_load_dwordx4 v[188:191], v11, s[26:27] offset:-1024 sc1
    s_sub_u32 s46, s46, 1
    s_cbranch_scc1 L_bail
    s_waitcnt vmcnt(0)
    v_max3_u32 v63, v176, v177, v178
    v_max3_u32 v63, v63, v179, v180
    v_max3_u32 v63, v63, v181, v182
    v_max3_u32 v63, v63, v183, v184
    v_max3_u32 v63, v63, v185, v186
    v_max3_u32 v63, v63, v187, v188
    v_max3_u32 v63, v63, v189, v190
    v_max_u32 v63, v63, v191
    v_cmp_eq_u32 vcc, -1, v63
    s_cbranch_vccnz Lpoll_35
    v_add_f32 v64, v176, v180
    v_add_f32 v68, v184, v188
    v_add_f32 v65, v177, v181
    v_add_f32 v69, v185, v189
    v_add_f32 v66, v178, v182
    v_add_f32 v70, v186, v190
    v_add_f32 v67, v179, v183
    v_add_f32 v71, v187, v191
    v_add_f32 v64, v64, v68
    v_add_f32 v65, v65, v69
    v_add_f32 v66, v66, v70
    v_add_f32 v67, v67, v71
    s_nop 0
    v_permlane32_swap_b32 v64, v66
    v_permlane32_swap_b32 v65, v67
    v_add_f32 v64, v64, v66
    v_add_f32 v65, v65, v67
    v_mov_b32 v66, v64
    v_mov_b32 v67, v65
    s_nop 0
    v_permlane16_swap_b32 v64, v66
    v_permlane16_swap_b32 v65, v67
    v_add_f32 v64, v64, v66
    v_add_f32 v65, v65, v67
    s_nop 0
    v_add_f32_dpp v64, v64, v64 row_ror:8 row_mask:0xf bank_mask:0xf
    v_add_f32_dpp v65, v65, v65 row_ror:8 row_mask:0xf bank_mask:0xf
    v_cvt_pk_bf16_f32 v66, v64, v65
    v_lshlrev_b32 v64, 16, v66
    v_and_b32 v65, 0xffff0000, v66
    v_add_f32 v64, v64, v18
    v_add_f32 v65, v65, v19
    v_cvt_pk_bf16_f32 v66, v64, v65
    s_mov_b32 s56, 0xff
    s_mov_b32 s57, 0xff
    v_min_u32 v67, -2, v66
    s_mov_b64 exec, s[56:57]
    s_cmp_lg_u32 s32, 0
    s_cbranch_scc0 Lslow_37
    global_store_dword v12, v67, s[26:27] offset:0
Lback_38:
    s_mov_b64 exec, -1
    v_lshlrev_b32 v18, 16, v66
    v_and_b32 v19, 0xffff0000, v66
    s_mov_b32 s46, 65536
Lpoll_39:
    global_load_dwordx4 v[148:151], v13, s[26:27] offset:0 sc1
    s_sub_u32 s46, s46, 1
    s_cbranch_scc1 L_bail
    s_waitcnt vmcnt(0)
    v_max3_u32 v63, v148, v149, v150
    v_max_u32 v63, v63, v151
    v_cmp_eq_u32 vcc, -1, v63
    s_cbranch_vccnz Lpoll_39
    v_mov_b32 v64, v148
    v_mov_b32 v65, v149
    v_mov_b32 v66, v150
    v_mov_b32 v67, v151
    s_nop 0
    v_permlane32_swap_b32 v64, v66
    v_permlane32_swap_b32 v65, v67
    v_add_f32 v64, v64, v66
    v_add_f32 v65, v65, v67
    v_mov_b32 v66, v64
    v_mov_b32 v67, v65
    s_nop 0
    v_permlane16_swap_b32 v64, v66
    v_permlane16_swap_b32 v65, v67
    v_add_f32 v64, v64, v66
    v_add_f32 v65, v65, v67
    s_nop 0
    v_add_f32_dpp v64, v64, v64 row_ror:8 row_mask:0xf bank_mask:0xf
    v_add_f32_dpp v65, v65, v65 row_ror:8 row_mask:0xf bank_mask:0xf
    v_cvt_pk_bf16_f32 v66, v64, v65
    v_lshlrev_b32 v64, 16, v66
    v_and_b32 v65, 0xffff0000, v66
    v_add_f32 v64, v64, v18
    v_add_f32 v65, v65, v19
    v_cvt_pk_bf16_f32 v66, v64, v65
    s_mov_b32 s56, 0xff
    s_mov_b32 s57, 0xff
    v_min_u32 v67, -2, v66
    s_mov_b64 exec, s[56:57]
    s_cmp_lg_u32 s32, 0
    s_cbranch_scc0 Lslow_41
    global_store_dword v12, v67, s[26:27] offset:1024
Lback_42:
    s_mov_b64 exec, -1
    v_lshlrev_b32 v18, 16, v66
    v_and_b32 v19, 0xffff0000, v66
    s_branch Lrd_33
Lr2_31:
    s_cmp_ge_u32 s29, 14
    s_cbranch_scc1 Lrd_33
    s_waitcnt vmcnt(0)
    ds_read_b64_tr_b16 a[128:129], v129 offset:0
    ds_read_b64_tr_b16 a[130:131], v129 offset:256
    ds_read_b64_tr_b16 a[132:133], v129 offset:32
    ds_read_b64_tr_b16 a[134:135], v129 offset:288
    ds_read_b64_tr_b16 a[136:137], v129 offset:2048
    ds_read_b64_tr_b16 a[138:139], v129 offset:2304
    ds_read_b64_tr_b16 a[140:141], v129 offset:2080
    ds_read_b64_tr_b16 a[142:143], v129 offset:2336
    ds_read_b64_tr_b16 a[144:145], v129 offset:4096
    ds_read_b64_tr_b16 a[146:147], v129 offset:4352
    ds_read_b64_tr_b16 a[148:149], v129 offset:4128
    ds_read_b64_tr_b16 a[150:151], v129 offset:4384
    ds_read_b64_tr_b16 a[152:153], v129 offset:6144
    ds_read_b64_tr_b16 a[154:155], v129 offset:6400
    ds_read_b64_tr_b16 a[156:157], v129 offset:6176
    ds_read_b64_tr_b16 a[158:159], v129 offset:6432
    ds_read_b64_tr_b16 a[160:161], v129 offset:8192
    ds_read_b64_tr_b16 a[162:163], v129 offset:8448
    ds_read_b64_tr_b16 a[164:165], v129 offset:8224
    ds_read_b64_tr_b16 a[166:167], v129 offset:8480
    ds_read_b64_tr_b16 a[168:169], v129 offset:10240
    ds_read_b64_tr_b16 a[170:171], v129 offset:10496
    ds_read_b64_tr_b16 a[172:173], v129 offset:10272
    ds_read_b64_tr_b16 a[174:175], v129 offset:10528
    ds_read_b64_tr_b16 a[176:177], v129 offset:12288
    ds_read_b64_tr_b16 a[178:179], v129 offset:12544
    ds_read_b64_tr_b16 a[180:181], v129 offset:12320
    ds_read_b64_tr_b16 a[182:183], v129 offset:12576
    s_waitcnt lgkmcnt(0)
    s_mov_b32 s46, 65536
Lpoll_43:
    global_load_dwordx4 v[148:151], v11, s[26:27] offset:0 sc1
    s_sub_u32 s46, s46, 1
    s_cbranch_scc1 L_bail
    s_waitcnt vmcnt(0)
    v_max3_u32 v63, v148, v149, v150
    v_max_u32 v63, v63, v151
    v_cmp_eq_u32 vcc, -1, v63
    s_cbranch_vccnz Lpoll_43
    v_mov_b32 v24, v148
    v_mov_b32 v25, v149
    v_mov_b32 v26, v150
    v_mov_b32 v27, v151
    v_mov_b32 v56, 0
    v_mov_b32 v57, 0
    v_mfma_f32_16x16x32_bf16 v[64:67], v[24:27], a[128:131], 0
    v_mfma_f32_16x16x32_bf16 v[68:71], v[24:27], a[132:135], 0
    v_mfma_f32_16x16x32_bf16 v[72:75], v[24:27], a[136:139], 0
    v_mfma_f32_16x16x32_bf16 v[76:79], v[24:27], a[140:143], 0
    v_mfma_f32_16x16x32_bf16 v[80:83], v[24:27], a[144:147], 0
    v_mfma_f32_16x16x32_bf16 v[84:87], v[24:27], a[148:151], 0
    s_nop 2
    v_add_f32_dpp v56, v64, v56 quad_perm:[0,1,2,3] row_mask:0x1 bank_mask:0xf
    v_mfma_f32_16x16x32_bf16 v[88:91], v[24:27], a[152:155], 0
    v_add_f32_dpp v57, v68, v57 quad_perm:[0,1,2,3] row_mask:0x1 bank_mask:0xf
    v_mfma_f32_16x16x32_bf16 v[92:95], v[24:27], a[156:159], 0
    v_add_f32_dpp v56, v73, v56 quad_perm:[0,1,2,3] row_mask:0x1 bank_mask:0xf
    v_mfma_f32_16x16x32_bf16 v[96:99], v[24:27], a[160:163], 0
    v_add_f32_dpp v57, v77, v57 quad_perm:[0,1,2,3] row_mask:0x1 bank_mask:0xf
    v_mfma_f32_16x16x32_bf16 v[100:103], v[24:27], a[164:167], 0
    v_add_f32_dpp v56, v82, v56 quad_perm:[0,1,2,3] row_mask:0x1 bank_mask:0xf
    v_mfma_f32_16x16x32_bf16 v[104:107], v[24:27], a[168:171], 0
    v_add_f32_dpp v57, v86, v57 quad_perm:[0,1,2,3] row_mask:0x1 bank_mask:0xf
    v_mfma_f32_16x16x32_bf16 v[108:111], v[24:27], a[172:175], 0
    v_add_f32_dpp v56, v91, v56 quad_perm:[0,1,2,3] row_mask:0x1 bank_mask:0xf
    v_mfma_f32_16x16x32_bf16 v[112:115], v[24:27], a[176:179], 0
    v_add_f32_dpp v57, v95, v57 quad_perm:[0,1,2,3] row_mask:0x1 bank_mask:0xf
    v_mfma_f32_16x16x32_bf16 v[116:119], v[24:27], a[180:183], 0
    v_add_f32_dpp v56, v96, v56 quad_perm:[0,1,2,3] row_mask:0x2 bank_mask:0xf
    v_add_f32_dpp v57, v100, v57 quad_perm:[0,1,2,3] row_mask:0x2 bank_mask:0xf
    v_add_f32_dpp v56, v105, v56 quad_perm:[0,1,2,3] row_mask:0x2 bank_mask:0xf
    s_nop 0
    v_add_f32_dpp v57, v109, v57 quad_perm:[0,1,2,3] row_mask:0x2 bank_mask:0xf
    s_nop 0
    v_add_f32_dpp v56, v114, v56 quad_perm:[0,1,2,3] row_mask:0x2 bank_mask:0xf
    s_nop 0
    v_add_f32_dpp v57, v118, v57 quad_perm:[0,1,2,3] row_mask:0x2 bank_mask:0xf
    s_nop 1
    v_permlane16_swap_b32 v56, v57
    v_add_f32 v56, v56, v57
    v_min_u32 v56, -2, v56
    v_mov_b32 v57, v56
    v_add_u32 v58, 0x10000, v12
    s_nop 0
    v_permlane32_swap_b32 v56, v57
    v_add_u32 v59, 0x20000, v12
    v_add_u32 v60, 0x30000, v12
    global_store_dword v12, v56, s[26:27] sc1
    global_store_dword v58, v56, s[26:27] sc1
    global_store_dword v59, v56, s[26:27] sc1
    global_store_dword v60, v56, s[26:27] sc1
    s_branch Lrd_33
Lr3_32:
    s_cmp_ge_u32 s29, 28
    s_cbranch_scc1 Lrd_33
    s_waitcnt vmcnt(0)
    ds_read_b64_tr_b16 a[128:129], v129 offset:0
    ds_read_b64_tr_b16 a[130:131], v129 offset:64
    ds_read_b64_tr_b16 a[132:133], v129 offset:512
    ds_read_b64_tr_b16 a[134:135], v129 offset:576
    ds_read_b64_tr_b16 a[136:137], v129 offset:1024
    ds_read_b64_tr_b16 a[138:139], v129 offset:1088
    ds_read_b64_tr_b16 a[140:141], v129 offset:1536
    ds_read_b64_tr_b16 a[142:143], v129 offset:1600
    ds_read_b64_tr_b16 a[144:145], v129 offset:2048
    ds_read_b64_tr_b16 a[146:147], v129 offset:2112
    ds_read_b64_tr_b16 a[148:149], v129 offset:2560
    ds_read_b64_tr_b16 a[150:151], v129 offset:2624
    ds_read_b64_tr_b16 a[152:153], v129 offset:3072
    ds_read_b64_tr_b16 a[154:155], v129 offset:3136
    ds_read_b64_tr_b16 a[156:157], v129 offset:3584
    ds_read_b64_tr_b16 a[158:159], v129 offset:3648
    ds_read_b64_tr_b16 a[160:161], v129 offset:4096
    ds_read_b64_tr_b16 a[162:163], v129 offset:4160
    ds_read_b64_tr_b16 a[164:165], v129 offset:4608
    ds_read_b64_tr_b16 a[166:167], v129 offset:4672
    ds_read_b64_tr_b16 a[168:169], v129 offset:5120
    ds_read_b64_tr_b16 a[170:171], v129 offset:5184
    ds_read_b64_tr_b16 a[172:173], v129 offset:5632
    ds_read_b64_tr_b16 a[174:175], v129 offset:5696
    ds_read_b64_tr_b16 a[176:177], v129 offset:6144
    ds_read_b64_tr_b16 a[178:179], v129 offset:6208
    ds_read_b64_tr_b16 a[180:181], v129 offset:6656
    ds_read_b64_tr_b16 a[182:183], v129 offset:6720
    s_waitcnt lgkmcnt(0)
    s_mov_b32 s46, 65536
Lpoll_45:
    global_load_dwordx4 v[148:151], v11, s[26:27] offset:0 sc1
    s_sub_u32 s46, s46, 1
    s_cbranch_scc1 L_bail
    s_waitcnt vmcnt(0)
    v_max3_u32 v63, v148, v149, v150
    v_max_u32 v63, v63, v151
    v_cmp_eq_u32 vcc, -1, v63
    s_cbranch_vccnz Lpoll_45
    v_mov_b32 v24, v148
    v_mov_b32 v25, v149
    v_mov_b32 v26, v150
    v_mov_b32 v27, v151
    v_dot2_f32_bf16 v57, v24, v48, 0
    v_dot2_f32_bf16 v58, v24, v24, 0
    v_dot2_f32_bf16 v57, v25, v48, v57
    v_dot2_f32_bf16 v58, v25, v25, v58
    v_dot2_f32_bf16 v57, v26, v48, v57
    v_dot2_f32_bf16 v58, v26, v26, v58
    v_dot2_f32_bf16 v57, v27, v48, v57
    v_dot2_f32_bf16 v58, v27, v27, v58
    v_lshlrev_b32 v100, 16, v24
    v_and_b32 v101, 0xffff0000, v24
    v_cndmask_b32 v57, 0, v57, s[48:49]
    v_cndmask_b32 v58, 0, v58, s[48:49]
    v_lshlrev_b32 v102, 16, v25
    v_add_f32_dpp v57, v57, v57 quad_perm:[1,0,3,2] row_mask:0xf bank_mask:0xf
    v_add_f32_dpp v58, v58, v58 quad_perm:[1,0,3,2] row_mask:0xf bank_mask:0xf
    v_and_b32 v103, 0xffff0000, v25
    v_add_f32_dpp v57, v57, v57 quad_perm:[2,3,0,1] row_mask:0xf bank_mask:0xf
    v_add_f32_dpp v58, v58, v58 quad_perm:[2,3,0,1] row_mask:0xf bank_mask:0xf
    v_lshlrev_b32 v104, 16, v26
    v_add_f32_dpp v57, v57, v57 row_half_mirror row_mask:0xf bank_mask:0xf
    v_add_f32_dpp v58, v58, v58 row_half_mirror row_mask:0xf bank_mask:0xf
    v_and_b32 v105, 0xffff0000, v26
    v_add_f32_dpp v57, v57, v57 row_mirror row_mask:0xf bank_mask:0xf
    v_add_f32_dpp v58, v58, v58 row_mirror row_mask:0xf bank_mask:0xf
    v_lshlrev_b32 v106, 16, v27
    v_and_b32 v107, 0xffff0000, v27
    v_permlane32_swap_b32 v57, v58
    v_add_f32 v57, v57, v58
    v_mov_b32 v58, v57
    v_mov_b32 v56, 0
    s_nop 0
    v_permlane16_swap_b32 v57, v58
    v_add_f32 v57, v57, v58
    s_nop 0
    v_readlane_b32 s50, v57, 0
    v_readlane_b32 s51, v57, 32
    s_nop 0
    v_mul_f32 v60, s50, v21
    v_mul_f32 v61, s51, v21
    v_fma_f32 v61, -v60, v60, v61
    v_max_f32 v61, 0, v61
    v_cvt_pk_bf16_f32 v59, v60, v61
    v_lshlrev_b32 v60, 16, v59
    v_and_b32 v61, 0xffff0000, v59
    v_add_f32 v61, 0x3727c5ac, v61
    v_cvt_pk_bf16_f32 v61, v61, v61
    v_and_b32 v61, 0xffff0000, v61
    v_sqrt_f32 v61, v61
    v_sub_f32 v100, v100, v60
    v_sub_f32 v101, v101, v60
    v_cvt_pk_bf16_f32 v61, v61, v61
    v_sub_f32 v102, v102, v60
    v_and_b32 v61, 0xffff0000, v61
    v_sub_f32 v103, v103, v60
    v_rcp_f32 v61, v61
    v_sub_f32 v104, v104, v60
    v_sub_f32 v105, v105, v60
    v_sub_f32 v106, v106, v60
    v_sub_f32 v107, v107, v60
    v_cvt_pk_bf16_f32 v24, v100, v101
    v_cvt_pk_bf16_f32 v25, v102, v103
    v_cvt_pk_bf16_f32 v26, v104, v105
    v_cvt_pk_bf16_f32 v27, v106, v107
    v_lshlrev_b32 v100, 16, v24
    v_and_b32 v101, 0xffff0000, v24
    v_lshlrev_b32 v102, 16, v25
    v_and_b32 v103, 0xffff0000, v25
    v_lshlrev_b32 v104, 16, v26
    v_and_b32 v105, 0xffff0000, v26
    v_lshlrev_b32 v106, 16, v27
    v_and_b32 v107, 0xffff0000, v27
    v_mul_f32 v100, v100, v61
    v_mul_f32 v101, v101, v61
    v_mul_f32 v102, v102, v61
    v_mul_f32 v103, v103, v61
    v_mul_f32 v104, v104, v61
    v_mul_f32 v105, v105, v61
    v_mul_f32 v106, v106, v61
    v_mul_f32 v107, v107, v61
    v_cvt_pk_bf16_f32 v24, v100, v101
    v_cvt_pk_bf16_f32 v25, v102, v103
    v_cvt_pk_bf16_f32 v26, v104, v105
    v_cvt_pk_bf16_f32 v27, v106, v107
    s_nop 1
    v_mfma_f32_16x16x32_bf16 v[64:67], v[24:27], a[128:131], 0
    v_mfma_f32_16x16x32_bf16 v[68:71], v[24:27], a[132:135], 0
    v_mfma_f32_16x16x32_bf16 v[72:75], v[24:27], a[136:139], 0
    v_mfma_f32_16x16x32_bf16 v[76:79], v[24:27], a[140:143], 0
    v_mfma_f32_16x16x32_bf16 v[80:83], v[24:27], a[144:147], 0
    v_mfma_f32_16x16x32_bf16 v[84:87], v[24:27], a[148:151], 0
    s_nop 2
    v_add_f32_dpp v56, v64, v56 quad_perm:[0,1,2,3] row_mask:0x1 bank_mask:0xf
    v_mfma_f32_16x16x32_bf16 v[88:91], v[24:27], a[152:155], 0
    v_add_f32_dpp v56, v69, v56 quad_perm:[0,1,2,3] row_mask:0x1 bank_mask:0xf
    v_mfma_f32_16x16x32_bf16 v[92:95], v[24:27], a[156:159], 0
    v_add_f32_dpp v56, v74, v56 quad_perm:[0,1,2,3] row_mask:0x1 bank_mask:0xf
    v_mfma_f32_16x16x32_bf16 v[96:99], v[24:27], a[160:163], 0
    v_add_f32_dpp v56, v79, v56 quad_perm:[0,1,2,3] row_mask:0x1 bank_mask:0xf
    v_mfma_f32_16x16x32_bf16 v[156:159], v[24:27], a[164:167], 0
    v_add_f32_dpp v56, v80, v56 quad_perm:[0,1,2,3] row_mask:0x2 bank_mask:0xf
    v_mfma_f32_16x16x32_bf16 v[160:163], v[24:27], a[168:171], 0
    v_add_f32_dpp v56, v85, v56 quad_perm:[0,1,2,3] row_mask:0x2 bank_mask:0xf
    v_mfma_f32_16x16x32_bf16 v[164:167], v[24:27], a[172:175], 0
    v_add_f32_dpp v56, v90, v56 quad_perm:[0,1,2,3] row_mask:0x2 bank_mask:0xf
    v_mfma_f32_16x16x32_bf16 v[168:171], v[24:27], a[176:179], 0
    v_add_f32_dpp v56, v95, v56 quad_perm:[0,1,2,3] row_mask:0x2 bank_mask:0xf
    v_mfma_f32_16x16x32_bf16 v[172:175], v[24:27], a[180:183], 0
    v_add_f32_dpp v56, v96, v56 quad_perm:[0,1,2,3] row_mask:0x4 bank_mask:0xf
    v_add_f32_dpp v56, v157, v56 quad_perm:[0,1,2,3] row_mask:0x4 bank_mask:0xf
    v_add_f32_dpp v56, v162, v56 quad_perm:[0,1,2,3] row_mask:0x4 bank_mask:0xf
    s_nop 0
    v_add_f32_dpp v56, v167, v56 quad_perm:[0,1,2,3] row_mask:0x4 bank_mask:0xf
    s_nop 0
    v_add_f32_dpp v56, v168, v56 quad_perm:[0,1,2,3] row_mask:0x8 bank_mask:0xf
    s_nop 0
    v_add_f32_dpp v56, v173, v56 quad_perm:[0,1,2,3] row_mask:0x8 bank_mask:0xf
    v_mov_b32 v59, v56
    s_nop 1
    v_permlane32_swap_b32 v56, v59
    v_add_f32 v56, v56, v59
    v_mov_b32 v59, v56
    s_nop 1
    v_permlane16_swap_b32 v56, v59
    v_add_f32 v56, v56, v59
    v_mul_f32 v58, 0xbfb8aa3b, v56
    v_exp_f32 v58, v58
    v_mov_b32_dpp v57, v56 row_shl:8 row_mask:0xf bank_mask:0xf
    v_add_f32 v58, 1.0, v58
    v_rcp_f32 v58, v58
    v_mul_f32 v57, v57, v56
    v_mul_f32 v56, v57, v58
    s_nop 1
    v_mov_b32_dpp v62, v56 row_shl:1 row_mask:0xf bank_mask:0xf
    v_cvt_pk_bf16_f32 v62, v56, v62
    v_min_u32 v62, -2, v62
    s_mov_b64 exec, 0x55
    s_cmp_lg_u32 s32, 0
    s_cbranch_scc0 Lslow_47
    global_store_dword v12, v62, s[26:27] offset:0
Lback_48:
    s_mov_b64 exec, -1
Lrd_33:
    s_cmp_lg_u32 s30, 0
    s_cbranch_scc1 Lnotw0_49
    global_load_dwordx4 v[176:179], v4, s[26:27] offset:1024 sc1
    s_mov_b32 s46, 65536
Lpoll_50:
    global_load_dwordx4 v[148:151], v11, s[26:27] offset:1024 sc1
    s_sub_u32 s46, s46, 1
    s_cbranch_scc1 L_bail
    s_waitcnt vmcnt(0)
    v_max3_u32 v63, v148, v149, v150
    v_max_u32 v63, v63, v151
    v_cmp_eq_u32 vcc, -1, v63
    s_cbranch_vccnz Lpoll_50
    v_mov_b32 v24, v148
    v_mov_b32 v25, v149
    v_mov_b32 v26, v150
    v_mov_b32 v27, v151
    v_dot2_f32_bf16 v57, v24, v48, 0
    v_dot2_f32_bf16 v58, v24, v24, 0
    v_dot2_f32_bf16 v57, v25, v48, v57
    v_dot2_f32_bf16 v58, v25, v25, v58
    v_dot2_f32_bf16 v57, v26, v48, v57
    v_dot2_f32_bf16 v58, v26, v26, v58
    v_dot2_f32_bf16 v57, v27, v48, v57
    v_dot2_f32_bf16 v58, v27, v27, v58
    v_lshlrev_b32 v100, 16, v24
    v_and_b32 v101, 0xffff0000, v24
    v_cndmask_b32 v57, 0, v57, s[48:49]
    v_cndmask_b32 v58, 0, v58, s[48:49]
    v_lshlrev_b32 v102, 16, v25
    v_add_f32_dpp v57, v57, v57 quad_perm:[1,0,3,2] row_mask:0xf bank_mask:0xf
    v_add_f32_dpp v58, v58, v58 quad_perm:[1,0,3,2] row_mask:0xf bank_mask:0xf
    v_and_b32 v103, 0xffff0000, v25
    v_add_f32_dpp v57, v57, v57 quad_perm:[2,3,0,1] row_mask:0xf bank_mask:0xf
    v_add_f32_dpp v58, v58, v58 quad_perm:[2,3,0,1] row_mask:0xf bank_mask:0xf
    v_lshlrev_b32 v104, 16, v26
    v_add_f32_dpp v57, v57, v57 row_half_mirror row_mask:0xf bank_mask:0xf
    v_add_f32_dpp v58, v58, v58 row_half_mirror row_mask:0xf bank_mask:0xf
    v_and_b32 v105, 0xffff0000, v26
    v_add_f32_dpp v57, v57, v57 row_mirror row_mask:0xf bank_mask:0xf
    v_add_f32_dpp v58, v58, v58 row_mirror row_mask:0xf bank_mask:0xf
    v_lshlrev_b32 v106, 16, v27
    v_and_b32 v107, 0xffff0000, v27
    v_permlane32_swap_b32 v57, v58
    v_add_f32 v57, v57, v58
    v_mov_b32 v58, v57
    v_mov_b32 v56, 0
    s_nop 0
    v_permlane16_swap_b32 v57, v58
    v_add_f32 v57, v57, v58
    s_nop 0
    v_readlane_b32 s50, v57, 0
    v_readlane_b32 s51, v57, 32
    s_nop 0
    v_mul_f32 v60, s50, v21
    v_mul_f32 v61, s51, v21
    v_fma_f32 v61, -v60, v60, v61
    v_max_f32 v61, 0, v61
    v_cvt_pk_bf16_f32 v59, v60, v61
    v_lshlrev_b32 v60, 16, v59
    v_and_b32 v61, 0xffff0000, v59
    v_add_f32 v61, 0x3727c5ac, v61
    v_cvt_pk_bf16_f32 v61, v61, v61
    v_and_b32 v61, 0xffff0000, v61
    v_sqrt_f32 v61, v61
    v_sub_f32 v100, v100, v60
    v_sub_f32 v101, v101, v60
    v_cvt_pk_bf16_f32 v61, v61, v61
    v_sub_f32 v102, v102, v60
    v_and_b32 v61, 0xffff0000, v61
    v_sub_f32 v103, v103, v60
    v_rcp_f32 v61, v61
    v_sub_f32 v104, v104, v60
    v_sub_f32 v105, v105, v60
    v_sub_f32 v106, v106, v60
    v_sub_f32 v107, v107, v60
    v_cvt_pk_bf16_f32 v24, v100, v101
    v_cvt_pk_bf16_f32 v25, v102, v103
    v_cvt_pk_bf16_f32 v26, v104, v105
    v_cvt_pk_bf16_f32 v27, v106, v107
    v_lshlrev_b32 v100, 16, v24
    v_and_b32 v101, 0xffff0000, v24
    v_lshlrev_b32 v102, 16, v25
    v_and_b32 v103, 0xffff0000, v25
    v_lshlrev_b32 v104, 16, v26
    v_and_b32 v105, 0xffff0000, v26
    v_lshlrev_b32 v106, 16, v27
    v_and_b32 v107, 0xffff0000, v27
    v_mul_f32 v100, v100, v61
    v_mul_f32 v101, v101, v61
    v_mul_f32 v102, v102, v61
    v_mul_f32 v103, v103, v61
    v_mul_f32 v104, v104, v61
    v_mul_f32 v105, v105, v61
    v_mul_f32 v106, v106, v61
    v_mul_f32 v107, v107, v61
    v_cvt_pk_bf16_f32 v24, v100, v101
    v_cvt_pk_bf16_f32 v25, v102, v103
    v_cvt_pk_bf16_f32 v26, v104, v105
    v_cvt_pk_bf16_f32 v27, v106, v107
    s_nop 1
    v_mfma_f32_16x16x32_bf16 v[64:67], v[24:27], a[128:131], 0
    v_mfma_f32_16x16x32_bf16 v[68:71], v[24:27], a[132:135], 0
    v_mfma_f32_16x16x32_bf16 v[72:75], v[24:27], a[136:139], 0
    v_mfma_f32_16x16x32_bf16 v[76:79], v[24:27], a[140:143], 0
    v_mfma_f32_16x16x32_bf16 v[80:83], v[24:27], a[144:147], 0
    v_mfma_f32_16x16x32_bf16 v[84:87], v[24:27], a[148:151], 0
    s_nop 2
    v_add_f32_dpp v56, v64, v56 quad_perm:[0,1,2,3] row_mask:0x1 bank_mask:0xf
    v_mfma_f32_16x16x32_bf16 v[88:91], v[24:27], a[152:155], 0
    v_add_f32_dpp v56, v69, v56 quad_perm:[0,1,2,3] row_mask:0x1 bank_mask:0xf
    v_mfma_f32_16x16x32_bf16 v[92:95], v[24:27], a[156:159], 0
    v_add_f32_dpp v56, v74, v56 quad_perm:[0,1,2,3] row_mask:0x1 bank_mask:0xf
    v_mfma_f32_16x16x32_bf16 v[96:99], v[24:27], a[160:163], 0
    v_add_f32_dpp v56, v79, v56 quad_perm:[0,1,2,3] row_mask:0x1 bank_mask:0xf
    v_mfma_f32_16x16x32_bf16 v[156:159], v[24:27], a[164:167], 0
    v_add_f32_dpp v56, v80, v56 quad_perm:[0,1,2,3] row_mask:0x2 bank_mask:0xf
    v_mfma_f32_16x16x32_bf16 v[160:163], v[24:27], a[168:171], 0
    v_add_f32_dpp v56, v85, v56 quad_perm:[0,1,2,3] row_mask:0x2 bank_mask:0xf
    v_mfma_f32_16x16x32_bf16 v[164:167], v[24:27], a[172:175], 0
    v_add_f32_dpp v56, v90, v56 quad_perm:[0,1,2,3] row_mask:0x2 bank_mask:0xf
    v_mfma_f32_16x16x32_bf16 v[168:171], v[24:27], a[176:179], 0
    v_add_f32_dpp v56, v95, v56 quad_perm:[0,1,2,3] row_mask:0x2 bank_mask:0xf
    v_mfma_f32_16x16x32_bf16 v[172:175], v[24:27], a[180:183], 0
    v_add_f32_dpp v56, v96, v56 quad_perm:[0,1,2,3] row_mask:0x4 bank_mask:0xf
    v_add_f32_dpp v56, v157, v56 quad_perm:[0,1,2,3] row_mask:0x4 bank_mask:0xf
    v_add_f32_dpp v56, v162, v56 quad_perm:[0,1,2,3] row_mask:0x4 bank_mask:0xf
    s_nop 0
    v_add_f32_dpp v56, v167, v56 quad_perm:[0,1,2,3] row_mask:0x4 bank_mask:0xf
    s_nop 0
    v_add_f32_dpp v56, v168, v56 quad_perm:[0,1,2,3] row_mask:0x8 bank_mask:0xf
    s_nop 0
    v_add_f32_dpp v56, v173, v56 quad_perm:[0,1,2,3] row_mask:0x8 bank_mask:0xf
    v_mov_b32 v59, v56
    s_nop 1
    v_permlane32_swap_b32 v56, v59
    v_add_f32 v56, v56, v59
    v_mov_b32 v59, v56
    s_nop 1
    v_permlane16_swap_b32 v56, v59
    v_add_f32 v56, v56, v59
    s_nop 1
    v_mov_b32_dpp v62, v56 row_shl:1 row_mask:0xf bank_mask:0xf
    v_cvt_pk_bf16_f32 v62, v56, v62
    v_min_u32 v62, -2, v62
    s_mov_b64 exec, 0x5555
    s_cmp_lg_u32 s32, 0
    s_cbranch_scc0 Lslow_52
    global_store_dword v12, v62, s[26:27] offset:1024
Lback_53:
    s_mov_b64 exec, -1
    s_mov_b32 s46, 65536
Lpoll_54:
    global_load_dwordx4 v[148:151], v4, s[26:27] offset:1024 sc1
    s_sub_u32 s46, s46, 1
    s_cbranch_scc1 L_bail
    s_waitcnt vmcnt(0)
    v_max3_u32 v63, v148, v149, v150
    v_max_u32 v63, v63, v151
    v_cmp_eq_u32 vcc, -1, v63
    s_cbranch_vccnz Lpoll_54
    v_mov_b32 v24, v148
    v_mov_b32 v25, v149
    v_mov_b32 v26, v150
    v_mov_b32 v27, v151
    ds_write_b128 v22, v[24:27]
    s_waitcnt lgkmcnt(0)
Lnotw0_49:
    s_barrier
    ds_read_b128 v[64:67], v146 offset:0
    ds_read_b128 v[68:71], v146 offset:32
    ds_read_b128 v[72:75], v146 offset:64
    ds_read_b128 v[76:79], v146 offset:96
    ds_read_b128 v[80:83], v146 offset:128
    ds_read_b128 v[84:87], v146 offset:160
    ds_read_b128 v[88:91], v146 offset:192
    ds_read_b128 v[92:95], v146 offset:224
    s_cmp_ge_u32 s30, 2
    s_cbranch_scc1 Lwarm_56
    global_load_dwordx4 v[176:179], v7, s[26:27] offset:1024 sc1
    global_load_dwordx4 v[180:183], v8, s[26:27] offset:1024 sc1
    global_load_dwordx2 v[192:193], v9, s[26:27] offset:512 sc1
Lwarm_56:
    s_waitcnt lgkmcnt(7)
    s_nop 0
    v_mfma_f32_16x16x32_bf16 v[36:39], a[0:3], v[64:67], 0
    v_mfma_f32_16x16x32_bf16 v[40:43], a[32:35], v[64:67], 0
    s_waitcnt lgkmcnt(6)
    v_mfma_f32_16x16x32_bf16 v[36:39], a[4:7], v[68:71], v[36:39]
    v_mfma_f32_16x16x32_bf16 v[40:43], a[36:39], v[68:71], v[40:43]
    s_waitcnt lgkmcnt(5)
    v_mfma_f32_16x16x32_bf16 v[36:39], a[8:11], v[72:75], v[36:39]
    v_mfma_f32_16x16x32_bf16 v[40:43], a[40:43], v[72:75], v[40:43]
    s_waitcnt lgkmcnt(4)
    v_mfma_f32_16x16x32_bf16 v[36:39], a[12:15], v[76:79], v[36:39]
    v_mfma_f32_16x16x32_bf16 v[40:43], a[44:47], v[76:79], v[40:43]
    s_waitcnt lgkmcnt(3)
    v_mfma_f32_16x16x32_bf16 v[36:39], a[16:19], v[80:83], v[36:39]
    v_mfma_f32_16x16x32_bf16 v[40:43], a[48:51], v[80:83], v[40:43]
    s_waitcnt lgkmcnt(2)
    v_mfma_f32_16x16x32_bf16 v[36:39], a[20:23], v[84:87], v[36:39]
    v_mfma_f32_16x16x32_bf16 v[40:43], a[52:55], v[84:87], v[40:43]
    s_waitcnt lgkmcnt(1)
    v_mfma_f32_16x16x32_bf16 v[36:39], a[24:27], v[88:91], v[36:39]
    v_mfma_f32_16x16x32_bf16 v[40:43], a[56:59], v[88:91], v[40:43]
    s_waitcnt lgkmcnt(0)
    v_mfma_f32_16x16x32_bf16 v[36:39], a[28:31], v[92:95], v[36:39]
    v_mfma_f32_16x16x32_bf16 v[40:43], a[60:63], v[92:95], v[40:43]
    s_nop 6
    v_cvt_pk_bf16_f32 v28, v36, v37
    v_cvt_pk_bf16_f32 v29, v38, v39
    v_cvt_pk_bf16_f32 v30, v40, v41
    v_cvt_pk_bf16_f32 v31, v42, v43
    v_lshlrev_b32 v36, 16, v28
    v_and_b32 v37, 0xffff0000, v28
    v_lshlrev_b32 v38, 16, v29
    v_and_b32 v39, 0xffff0000, v29
    v_lshlrev_b32 v40, 16, v30
    v_and_b32 v41, 0xffff0000, v30
    v_lshlrev_b32 v42, 16, v31
    v_and_b32 v43, 0xffff0000, v31
    v_max3_f32 v56, v36, v37, v38
    v_max3_f32 v57, v39, v40, v41
    v_max3_f32 v56, v56, v42, v43
    v_max_f32 v56, v56, v57
    v_mov_b32 v57, v56
    s_nop 1
    v_permlane32_swap_b32 v56, v57
    v_max_f32 v56, v56, v57
    v_mov_b32 v57, v56
    s_nop 1
    v_permlane16_swap_b32 v56, v57
    v_max_f32 v56, v56, v57
    s_mov_b64 exec, 0x3
    ds_write_b32 v16, v56
    s_mov_b64 exec, -1
    s_waitcnt lgkmcnt(0)
    s_barrier
    ds_read_b128 v[64:67], v144
    s_mov_b32 s56, 0x00030003
    s_mov_b32 s57, 0x00030003
    s_waitcnt lgkmcnt(0)
    v_max3_f32 v56, v64, v65, v66
    v_max_f32 v56, v56, v67
    v_mul_f32 v58, s52, v56
    v_fma_f32 v36, v36, s52, -v58
    v_fma_f32 v37, v37, s52, -v58
    v_fma_f32 v38, v38, s52, -v58
    v_fma_f32 v39, v39, s52, -v58
    v_fma_f32 v40, v40, s52, -v58
    v_fma_f32 v41, v41, s52, -v58
    v_fma_f32 v42, v42, s52, -v58
    v_fma_f32 v43, v43, s52, -v58
    v_exp_f32 v36, v36
    v_exp_f32 v37, v37
    v_exp_f32 v38, v38
    v_exp_f32 v39, v39
    v_exp_f32 v40, v40
    v_exp_f32 v41, v41
    v_exp_f32 v42, v42
    v_exp_f32 v43, v43
    v_cvt_pk_bf16_f32 v44, v36, v37
    v_cvt_pk_bf16_f32 v45, v38, v39
    v_cvt_pk_bf16_f32 v46, v40, v41
    v_cvt_pk_bf16_f32 v47, v42, v43
    s_mov_b64 exec, s[56:57]
    ds_write_b128 v14, v[44:47]
    s_mov_b64 exec, -1
    s_waitcnt lgkmcnt(0)
    s_barrier
    ds_read_b128 v[96:99], v15 offset:0
    ds_read_b128 v[100:103], v15 offset:128
    ds_read_b128 v[104:107], v15 offset:256
    ds_read_b128 v[108:111], v15 offset:384
    s_cmp_lg_u32 s30, 3
    s_cbranch_scc1 Lnol_57
    s_waitcnt lgkmcnt(0)
    v_mfma_f32_16x16x32_bf16 v[52:55], v[48:51], v[96:99], 0
    v_mfma_f32_16x16x32_bf16 v[52:55], v[48:51], v[100:103], v[52:55]
    v_mfma_f32_16x16x32_bf16 v[52:55], v[48:51], v[104:107], v[52:55]
    v_mfma_f32_16x16x32_bf16 v[52:55], v[48:51], v[108:111], v[52:55]
Lnol_57:
    s_waitcnt lgkmcnt(3)
    v_mfma_f32_16x16x32_bf16 v[64:67], a[64:67], v[96:99], 0
    v_mfma_f32_16x16x32_bf16 v[68:71], a[68:71], v[96:99], 0
    v_mfma_f32_16x16x32_bf16 v[72:75], a[72:75], v[96:99], 0
    v_mfma_f32_16x16x32_bf16 v[76:79], a[76:79], v[96:99], 0
    s_waitcnt lgkmcnt(2)
    v_mfma_f32_16x16x32_bf16 v[64:67], a[80:83], v[100:103], v[64:67]
    v_mfma_f32_16x16x32_bf16 v[68:71], a[84:87], v[100:103], v[68:71]
    v_mfma_f32_16x16x32_bf16 v[72:75], a[88:91], v[100:103], v[72:75]
    v_mfma_f32_16x16x32_bf16 v[76:79], a[92:95], v[100:103], v[76:79]
    s_waitcnt lgkmcnt(1)
    v_mfma_f32_16x16x32_bf16 v[64:67], a[96:99], v[104:107], v[64:67]
    v_mfma_f32_16x16x32_bf16 v[68:71], a[100:103], v[104:107], v[68:71]
    v_mfma_f32_16x16x32_bf16 v[72:75], a[104:107], v[104:107], v[72:75]
    v_mfma_f32_16x16x32_bf16 v[76:79], a[108:111], v[104:107], v[76:79]
    s_waitcnt lgkmcnt(0)
    v_mfma_f32_16x16x32_bf16 v[64:67], a[112:115], v[108:111], v[64:67]
    v_mfma_f32_16x16x32_bf16 v[68:71], a[116:119], v[108:111], v[68:71]
    v_mfma_f32_16x16x32_bf16 v[72:75], a[120:123], v[108:111], v[72:75]
    v_mfma_f32_16x16x32_bf16 v[76:79], a[124:127], v[108:111], v[76:79]
    s_nop 4
    v_cvt_pk_bf16_f32 v80, v64, v65
    v_cvt_pk_bf16_f32 v81, v66, v67
    v_cvt_pk_bf16_f32 v82, v68, v69
    v_cvt_pk_bf16_f32 v83, v70, v71
    v_min_u32 v80, -2, v80
    v_min_u32 v81, -2, v81
    v_min_u32 v82, -2, v82
    v_min_u32 v83, -2, v83
    v_cvt_pk_bf16_f32 v84, v72, v73
    v_cvt_pk_bf16_f32 v85, v74, v75
    v_cvt_pk_bf16_f32 v86, v76, v77
    v_cvt_pk_bf16_f32 v87, v78, v79
    v_min_u32 v84, -2, v84
    v_min_u32 v85, -2, v85
    v_min_u32 v86, -2, v86
    v_min_u32 v87, -2, v87
    s_mov_b64 exec, s[56:57]
    s_cmp_lg_u32 s32, 0
    s_cbranch_scc0 Lslow_58
    global_store_dwordx4 v5, v[80:83], s[26:27] offset:1024
    global_store_dwordx4 v5, v[84:87], s[26:27] offset:1088
    s_nop 1
Lback_59:
    s_cmp_lg_u32 s30, 3
    s_cbranch_scc1 Lnost_60
    v_min_u32 v58, -2, v58
    v_min_u32 v59, -2, v52
    s_mov_b64 exec, 0x3
    s_cmp_lg_u32 s32, 0
    s_cbranch_scc0 Lslow_61
    global_store_dwordx2 v6, v[58:59], s[26:27] offset:512
Lback_62:
Lnost_60:
    s_mov_b64 exec, -1
    s_cmp_ge_u32 s29, 28
    s_cbranch_scc1 Lnop3_63
    s_cmp_ge_u32 s30, 2
    s_cbranch_scc1 Lp3bar_64
    s_mov_b32 s46, 65536
Lpoll_65:
    global_load_dwordx4 v[156:159], v7, s[26:27] offset:1024 sc1
    global_load_dwordx4 v[160:163], v8, s[26:27] offset:1024 sc1
    global_load_dwordx4 v[164:167], v7, s[26:27] offset:1088 sc1
    global_load_dwordx4 v[168:171], v8, s[26:27] offset:1088 sc1
    global_load_dwordx2 v[172:173], v9, s[26:27] offset:512 sc1
    s_sub_u32 s46, s46, 1
    s_cbranch_scc1 L_bail
    s_waitcnt vmcnt(0)
    v_max3_u32 v63, v156, v157, v158
    v_max3_u32 v63, v63, v159, v160
    v_max3_u32 v63, v63, v161, v162
    v_max3_u32 v63, v63, v163, v164
    v_max3_u32 v63, v63, v165, v166
    v_max3_u32 v63, v63, v167, v168
    v_max3_u32 v63, v63, v169, v170
    v_max3_u32 v63, v63, v171, v172
    v_max_u32 v63, v63, v173
    v_cmp_eq_u32 vcc, -1, v63
    s_cbranch_vccnz Lpoll_65
    v_mov_b32 v32, v172
    v_mov_b32 v33, v173
    v_mfma_f32_16x16x32_bf16 v[64:67], v[156:159], a[184:187], 0
    v_mfma_f32_16x16x32_bf16 v[68:71], v[160:163], a[184:187], 0
    v_mfma_f32_16x16x32_bf16 v[72:75], v[156:159], a[188:191], 0
    v_mfma_f32_16x16x32_bf16 v[76:79], v[160:163], a[188:191], 0
    v_mfma_f32_16x16x32_bf16 v[80:83], v[156:159], a[192:195], 0
    v_mfma_f32_16x16x32_bf16 v[84:87], v[160:163], a[192:195], 0
    v_mfma_f32_16x16x32_bf16 v[88:91], v[156:159], a[196:199], 0
    v_mfma_f32_16x16x32_bf16 v[92:95], v[160:163], a[196:199], 0
    v_mfma_f32_16x16x32_bf16 v[64:67], v[164:167], a[200:203], v[64:67]
    v_mfma_f32_16x16x32_bf16 v[68:71], v[168:171], a[200:203], v[68:71]
    v_mfma_f32_16x16x32_bf16 v[72:75], v[164:167], a[204:207], v[72:75]
    v_mfma_f32_16x16x32_bf16 v[76:79], v[168:171], a[204:207], v[76:79]
    v_mfma_f32_16x16x32_bf16 v[80:83], v[164:167], a[208:211], v[80:83]
    v_mfma_f32_16x16x32_bf16 v[84:87], v[168:171], a[208:211], v[84:87]
    v_mfma_f32_16x16x32_bf16 v[88:91], v[164:167], a[212:215], v[88:91]
    v_mfma_f32_16x16x32_bf16 v[92:95], v[168:171], a[212:215], v[92:95]
    v_mov_b32 v56, v32
    s_nop 1
    v_max_f32_dpp v56, v56, v56 quad_perm:[1,0,3,2] row_mask:0xf bank_mask:0xf
    s_nop 1
    v_max_f32_dpp v56, v56, v56 quad_perm:[2,3,0,1] row_mask:0xf bank_mask:0xf
    s_nop 1
    v_max_f32_dpp v56, v56, v56 row_half_mirror row_mask:0xf bank_mask:0xf
    v_mov_b32 v57, v56
    s_nop 1
    v_permlane32_swap_b32 v56, v57
    v_max_f32 v56, v56, v57
    v_mov_b32 v57, v56
    s_nop 1
    v_permlane16_swap_b32 v56, v57
    v_max_f32 v56, v56, v57
    v_sub_f32 v58, v32, v56
    v_exp_f32 v58, v58
    s_nop 1
    v_mul_f32_dpp v100, v58, v64 row_newbcast:0 row_mask:0xf bank_mask:0xf
    v_mul_f32_dpp v101, v58, v72 row_newbcast:0 row_mask:0xf bank_mask:0xf
    v_mul_f32 v59, v58, v33
    v_mul_f32_dpp v102, v58, v80 row_newbcast:0 row_mask:0xf bank_mask:0xf
    v_mul_f32_dpp v103, v58, v88 row_newbcast:0 row_mask:0xf bank_mask:0xf
    v_add_f32_dpp v59, v59, v59 quad_perm:[1,0,3,2] row_mask:0xf bank_mask:0xf
    v_fmac_f32_dpp v100, v58, v65 row_newbcast:1 row_mask:0xf bank_mask:0xf
    v_fmac_f32_dpp v101, v58, v73 row_newbcast:1 row_mask:0xf bank_mask:0xf
    v_add_f32_dpp v59, v59, v59 quad_perm:[2,3,0,1] row_mask:0xf bank_mask:0xf
    v_fmac_f32_dpp v102, v58, v81 row_newbcast:1 row_mask:0xf bank_mask:0xf
    v_fmac_f32_dpp v103, v58, v89 row_newbcast:1 row_mask:0xf bank_mask:0xf
    v_add_f32_dpp v59, v59, v59 row_half_mirror row_mask:0xf bank_mask:0xf
    v_fmac_f32_dpp v100, v58, v66 row_newbcast:2 row_mask:0xf bank_mask:0xf
    v_fmac_f32_dpp v101, v58, v74 row_newbcast:2 row_mask:0xf bank_mask:0xf
    v_mov_b32 v57, v59
    v_fmac_f32_dpp v102, v58, v82 row_newbcast:2 row_mask:0xf bank_mask:0xf
    v_fmac_f32_dpp v103, v58, v90 row_newbcast:2 row_mask:0xf bank_mask:0xf
    v_permlane32_swap_b32 v59, v57
    v_fmac_f32_dpp v100, v58, v67 row_newbcast:3 row_mask:0xf bank_mask:0xf
    v_fmac_f32_dpp v101, v58, v75 row_newbcast:3 row_mask:0xf bank_mask:0xf
    v_add_f32 v59, v59, v57
    v_fmac_f32_dpp v102, v58, v83 row_newbcast:3 row_mask:0xf bank_mask:0xf
    v_fmac_f32_dpp v103, v58, v91 row_newbcast:3 row_mask:0xf bank_mask:0xf
    v_mov_b32 v57, v59
    v_fmac_f32_dpp v100, v58, v68 row_newbcast:4 row_mask:0xf bank_mask:0xf
    v_fmac_f32_dpp v101, v58, v76 row_newbcast:4 row_mask:0xf bank_mask:0xf
    v_permlane16_swap_b32 v59, v57
    v_fmac_f32_dpp v102, v58, v84 row_newbcast:4 row_mask:0xf bank_mask:0xf
    v_fmac_f32_dpp v103, v58, v92 row_newbcast:4 row_mask:0xf bank_mask:0xf
    v_add_f32 v59, v59, v57
    v_fmac_f32_dpp v100, v58, v69 row_newbcast:5 row_mask:0xf bank_mask:0xf
    v_fmac_f32_dpp v101, v58, v77 row_newbcast:5 row_mask:0xf bank_mask:0xf
    v_rcp_f32 v59, v59
    v_fmac_f32_dpp v102, v58, v85 row_newbcast:5 row_mask:0xf bank_mask:0xf
    v_fmac_f32_dpp v103, v58, v93 row_newbcast:5 row_mask:0xf bank_mask:0xf
    v_fmac_f32_dpp v100, v58, v70 row_newbcast:6 row_mask:0xf bank_mask:0xf
    v_fmac_f32_dpp v101, v58, v78 row_newbcast:6 row_mask:0xf bank_mask:0xf
    v_fmac_f32_dpp v102, v58, v86 row_newbcast:6 row_mask:0xf bank_mask:0xf
    v_fmac_f32_dpp v103, v58, v94 row_newbcast:6 row_mask:0xf bank_mask:0xf
    v_fmac_f32_dpp v100, v58, v71 row_newbcast:7 row_mask:0xf bank_mask:0xf
    v_fmac_f32_dpp v101, v58, v79 row_newbcast:7 row_mask:0xf bank_mask:0xf
    v_fmac_f32_dpp v102, v58, v87 row_newbcast:7 row_mask:0xf bank_mask:0xf
    v_fmac_f32_dpp v103, v58, v95 row_newbcast:7 row_mask:0xf bank_mask:0xf
    s_nop 0
    v_permlane32_swap_b32 v100, v102
    v_permlane32_swap_b32 v101, v103
    v_add_f32 v100, v100, v102
    v_add_f32 v101, v101, v103
    s_nop 1
    v_permlane16_swap_b32 v100, v101
    v_add_f32 v100, v100, v101
    v_mul_f32 v100, v100, v59
    s_mov_b32 s46, 4194304
    s_cmp_lg_u32 s30, 0
    s_cbranch_scc0 Lspin_68
    v_min_u32 v100, -2, v100
    ds_write_b32 v23, v100 offset:256
    s_branch Lnotw0c_67
Lspin_68:
    ds_read_b32 v101, v23 offset:256
    s_sub_u32 s46, s46, 1
    s_cbranch_scc1 L_bail
    s_waitcnt lgkmcnt(0)
    v_cmp_eq_u32 vcc, -1, v101
    s_cbranch_vccnz Lspin_68
    v_add_f32 v100, v100, v101
    v_min_u32 v100, -2, v100
    global_store_dword v10, v100, s[26:27] offset:2048 sc1
Lnotw0c_67:
Lp3bar_64:
Lnop3_63:
    s_cmp_eq_u32 s30, 1
    s_cbranch_scc1 Lr1_69
    s_cmp_eq_u32 s30, 2
    s_cbranch_scc1 Lr2_70
    s_cmp_eq_u32 s30, 3
    s_cbranch_scc1 Lr3_71
    s_branch Lrd_72
Lr1_69:
    s_cmp_ge_u32 s29, 14
    s_cbranch_scc1 Lrd_72
    s_sleep 16
    s_mov_b32 s46, 65536
Lpoll_73:
    global_load_dwordx4 v[176:179], v11, s[26:27] offset:0 sc1
    global_load_dwordx4 v[180:183], v11, s[26:27] offset:1024 sc1
    global_load_dwordx4 v[184:187], v11, s[26:27] offset:2048 sc1
    global_load_dwordx4 v[188:191], v11, s[26:27] offset:3072 sc1
    s_sub_u32 s46, s46, 1
    s_cbranch_scc1 L_bail
    s_waitcnt vmcnt(0)
    v_max3_u32 v63, v176, v177, v178
    v_max3_u32 v63, v63, v179, v180
    v_max3_u32 v63, v63, v181, v182
    v_max3_u32 v63, v63, v183, v184
    v_max3_u32 v63, v63, v185, v186
    v_max3_u32 v63, v63, v187, v188
    v_max3_u32 v63, v63, v189, v190
    v_max_u32 v63, v63, v191
    v_cmp_eq_u32 vcc, -1, v63
    s_cbranch_vccnz Lpoll_73
    v_add_f32 v64, v176, v180
    v_add_f32 v68, v184, v188
    v_add_f32 v65, v177, v181
    v_add_f32 v69, v185, v189
    v_add_f32 v66, v178, v182
    v_add_f32 v70, v186, v190
    v_add_f32 v67, v179, v183
    v_add_f32 v71, v187, v191
    v_add_f32 v64, v64, v68
    v_add_f32 v65, v65, v69
    v_add_f32 v66, v66, v70
    v_add_f32 v67, v67, v71
    s_nop 0
    v_permlane32_swap_b32 v64, v66
    v_permlane32_swap_b32 v65, v67
    v_add_f32 v64, v64, v66
    v_add_f32 v65, v65, v67
    v_mov_b32 v66, v64
    v_mov_b32 v67, v65
    s_nop 0
    v_permlane16_swap_b32 v64, v66
    v_permlane16_swap_b32 v65, v67
    v_add_f32 v64, v64, v66
    v_add_f32 v65, v65, v67
    s_nop 0
    v_add_f32_dpp v64, v64, v64 row_ror:8 row_mask:0xf bank_mask:0xf
    v_add_f32_dpp v65, v65, v65 row_ror:8 row_mask:0xf bank_mask:0xf
    v_cvt_pk_bf16_f32 v66, v64, v65
    v_lshlrev_b32 v64, 16, v66
    v_and_b32 v65, 0xffff0000, v66
    v_add_f32 v64, v64, v18
    v_add_f32 v65, v65, v19
    v_cvt_pk_bf16_f32 v66, v64, v65
    s_mov_b32 s56, 0xff
    s_mov_b32 s57, 0xff
    v_min_u32 v67, -2, v66
    s_mov_b64 exec, s[56:57]
    s_cmp_lg_u32 s32, 0
    s_cbranch_scc0 Lslow_75
    global_store_dword v12, v67, s[26:27] offset:2048
Lback_76:
    s_mov_b64 exec, -1
    v_lshlrev_b32 v18, 16, v66
    v_and_b32 v19, 0xffff0000, v66
    s_cmp_lg_u32 s28, 0
    s_cbranch_scc1 Lrd_72
    s_mov_b32 s46, 65536
Lpoll_77:
    global_load_dwordx4 v[148:151], v13, s[26:27] offset:1024 sc1
    s_sub_u32 s46, s46, 1
    s_cbranch_scc1 L_bail
    s_waitcnt vmcnt(0)
    v_max3_u32 v63, v148, v149, v150
    v_max_u32 v63, v63, v151
    v_cmp_eq_u32 vcc, -1, v63
    s_cbranch_vccnz Lpoll_77
    v_mov_b32 v64, v148
    v_mov_b32 v65, v149
    v_mov_b32 v66, v150
    v_mov_b32 v67, v151
    s_nop 0
    v_permlane32_swap_b32 v64, v66
    v_permlane32_swap_b32 v65, v67
    v_add_f32 v64, v64, v66
    v_add_f32 v65, v65, v67
    v_mov_b32 v66, v64
    v_mov_b32 v67, v65
    s_nop 0
    v_permlane16_swap_b32 v64, v66
    v_permlane16_swap_b32 v65, v67
    v_add_f32 v64, v64, v66
    v_add_f32 v65, v65, v67
    s_nop 0
    v_add_f32_dpp v64, v64, v64 row_ror:8 row_mask:0xf bank_mask:0xf
    v_add_f32_dpp v65, v65, v65 row_ror:8 row_mask:0xf bank_mask:0xf
    v_cvt_pk_bf16_f32 v66, v64, v65
    v_lshlrev_b32 v64, 16, v66
    v_and_b32 v65, 0xffff0000, v66
    v_add_f32 v64, v64, v18
    v_add_f32 v65, v65, v19
    v_cvt_pk_bf16_f32 v66, v64, v65
    s_mov_b32 s56, 0xff
    s_mov_b32 s57, 0xff
    s_mov_b64 exec, s[56:57]
    global_store_dword v20, v66, s[22:23]
    s_mov_b64 exec, -1
    v_lshlrev_b32 v18, 16, v66
    v_and_b32 v19, 0xffff0000, v66
    s_branch Lrd_72
Lr2_70:
    s_cmp_ge_u32 s29, 14
    s_cbranch_scc1 Lrd_72
    s_mov_b32 s46, 65536
Lpoll_79:
    global_load_dwordx4 v[148:151], v11, s[26:27] offset:512 sc1
    s_sub_u32 s46, s46, 1
    s_cbranch_scc1 L_bail
    s_waitcnt vmcnt(0)
    v_max3_u32 v63, v148, v149, v150
    v_max_u32 v63, v63, v151
    v_cmp_eq_u32 vcc, -1, v63
    s_cbranch_vccnz Lpoll_79
    v_mov_b32 v24, v148
    v_mov_b32 v25, v149
    v_mov_b32 v26, v150
    v_mov_b32 v27, v151
    v_mov_b32 v56, 0
    v_mov_b32 v57, 0
    v_mfma_f32_16x16x32_bf16 v[64:67], v[24:27], a[128:131], 0
    v_mfma_f32_16x16x32_bf16 v[68:71], v[24:27], a[132:135], 0
    v_mfma_f32_16x16x32_bf16 v[72:75], v[24:27], a[136:139], 0
    v_mfma_f32_16x16x32_bf16 v[76:79], v[24:27], a[140:143], 0
    v_mfma_f32_16x16x32_bf16 v[80:83], v[24:27], a[144:147], 0
    v_mfma_f32_16x16x32_bf16 v[84:87], v[24:27], a[148:151], 0
    s_nop 2
    v_add_f32_dpp v56, v64, v56 quad_perm:[0,1,2,3] row_mask:0x1 bank_mask:0xf
    v_mfma_f32_16x16x32_bf16 v[88:91], v[24:27], a[152:155], 0
    v_add_f32_dpp v57, v68, v57 quad_perm:[0,1,2,3] row_mask:0x1 bank_mask:0xf
    v_mfma_f32_16x16x32_bf16 v[92:95], v[24:27], a[156:159], 0
    v_add_f32_dpp v56, v73, v56 quad_perm:[0,1,2,3] row_mask:0x1 bank_mask:0xf
    v_mfma_f32_16x16x32_bf16 v[96:99], v[24:27], a[160:163], 0
    v_add_f32_dpp v57, v77, v57 quad_perm:[0,1,2,3] row_mask:0x1 bank_mask:0xf
    v_mfma_f32_16x16x32_bf16 v[100:103], v[24:27], a[164:167], 0
    v_add_f32_dpp v56, v82, v56 quad_perm:[0,1,2,3] row_mask:0x1 bank_mask:0xf
    v_mfma_f32_16x16x32_bf16 v[104:107], v[24:27], a[168:171], 0
    v_add_f32_dpp v57, v86, v57 quad_perm:[0,1,2,3] row_mask:0x1 bank_mask:0xf
    v_mfma_f32_16x16x32_bf16 v[108:111], v[24:27], a[172:175], 0
    v_add_f32_dpp v56, v91, v56 quad_perm:[0,1,2,3] row_mask:0x1 bank_mask:0xf
    v_mfma_f32_16x16x32_bf16 v[112:115], v[24:27], a[176:179], 0
    v_add_f32_dpp v57, v95, v57 quad_perm:[0,1,2,3] row_mask:0x1 bank_mask:0xf
    v_mfma_f32_16x16x32_bf16 v[116:119], v[24:27], a[180:183], 0
    v_add_f32_dpp v56, v96, v56 quad_perm:[0,1,2,3] row_mask:0x2 bank_mask:0xf
    v_add_f32_dpp v57, v100, v57 quad_perm:[0,1,2,3] row_mask:0x2 bank_mask:0xf
    v_add_f32_dpp v56, v105, v56 quad_perm:[0,1,2,3] row_mask:0x2 bank_mask:0xf
    s_nop 0
    v_add_f32_dpp v57, v109, v57 quad_perm:[0,1,2,3] row_mask:0x2 bank_mask:0xf
    s_nop 0
    v_add_f32_dpp v56, v114, v56 quad_perm:[0,1,2,3] row_mask:0x2 bank_mask:0xf
    s_nop 0
    v_add_f32_dpp v57, v118, v57 quad_perm:[0,1,2,3] row_mask:0x2 bank_mask:0xf
    s_nop 1
    v_permlane16_swap_b32 v56, v57
    v_add_f32 v56, v56, v57
    v_min_u32 v56, -2, v56
    s_mov_b64 exec, 0xffffffff
    global_store_dword v12, v56, s[26:27] offset:1024 sc1
    s_mov_b64 exec, -1
    s_branch Lrd_72
Lr3_71:
    s_cmp_ge_u32 s29, 28
    s_cbranch_scc1 Lrd_72
    s_mov_b32 s46, 65536
Lpoll_81:
    global_load_dwordx4 v[148:151], v11, s[26:27] offset:2048 sc1
    s_sub_u32 s46, s46, 1
    s_cbranch_scc1 L_bail
    s_waitcnt vmcnt(0)
    v_max3_u32 v63, v148, v149, v150
    v_max_u32 v63, v63, v151
    v_cmp_eq_u32 vcc, -1, v63
    s_cbranch_vccnz Lpoll_81
    v_mov_b32 v24, v148
    v_mov_b32 v25, v149
    v_mov_b32 v26, v150
    v_mov_b32 v27, v151
    v_dot2_f32_bf16 v57, v24, v48, 0
    v_dot2_f32_bf16 v58, v24, v24, 0
    v_dot2_f32_bf16 v57, v25, v48, v57
    v_dot2_f32_bf16 v58, v25, v25, v58
    v_dot2_f32_bf16 v57, v26, v48, v57
    v_dot2_f32_bf16 v58, v26, v26, v58
    v_dot2_f32_bf16 v57, v27, v48, v57
    v_dot2_f32_bf16 v58, v27, v27, v58
    v_lshlrev_b32 v100, 16, v24
    v_and_b32 v101, 0xffff0000, v24
    v_cndmask_b32 v57, 0, v57, s[48:49]
    v_cndmask_b32 v58, 0, v58, s[48:49]
    v_lshlrev_b32 v102, 16, v25
    v_add_f32_dpp v57, v57, v57 quad_perm:[1,0,3,2] row_mask:0xf bank_mask:0xf
    v_add_f32_dpp v58, v58, v58 quad_perm:[1,0,3,2] row_mask:0xf bank_mask:0xf
    v_and_b32 v103, 0xffff0000, v25
    v_add_f32_dpp v57, v57, v57 quad_perm:[2,3,0,1] row_mask:0xf bank_mask:0xf
    v_add_f32_dpp v58, v58, v58 quad_perm:[2,3,0,1] row_mask:0xf bank_mask:0xf
    v_lshlrev_b32 v104, 16, v26
    v_add_f32_dpp v57, v57, v57 row_half_mirror row_mask:0xf bank_mask:0xf
    v_add_f32_dpp v58, v58, v58 row_half_mirror row_mask:0xf bank_mask:0xf
    v_and_b32 v105, 0xffff0000, v26
    v_add_f32_dpp v57, v57, v57 row_mirror row_mask:0xf bank_mask:0xf
    v_add_f32_dpp v58, v58, v58 row_mirror row_mask:0xf bank_mask:0xf
    v_lshlrev_b32 v106, 16, v27
    v_and_b32 v107, 0xffff0000, v27
    v_permlane32_swap_b32 v57, v58
    v_add_f32 v57, v57, v58
    v_mov_b32 v58, v57
    v_mov_b32 v56, 0
    s_nop 0
    v_permlane16_swap_b32 v57, v58
    v_add_f32 v57, v57, v58
    s_nop 0
    v_readlane_b32 s50, v57, 0
    v_readlane_b32 s51, v57, 32
    s_nop 0
    v_mul_f32 v60, s50, v21
    v_mul_f32 v61, s51, v21
    v_fma_f32 v61, -v60, v60, v61
    v_max_f32 v61, 0, v61
    v_cvt_pk_bf16_f32 v59, v60, v61
    v_lshlrev_b32 v60, 16, v59
    v_and_b32 v61, 0xffff0000, v59
    v_add_f32 v61, 0x3727c5ac, v61
    v_cvt_pk_bf16_f32 v61, v61, v61
    v_and_b32 v61, 0xffff0000, v61
    v_sqrt_f32 v61, v61
    v_sub_f32 v100, v100, v60
    v_sub_f32 v101, v101, v60
    v_cvt_pk_bf16_f32 v61, v61, v61
    v_sub_f32 v102, v102, v60
    v_and_b32 v61, 0xffff0000, v61
    v_sub_f32 v103, v103, v60
    v_rcp_f32 v61, v61
    v_sub_f32 v104, v104, v60
    v_sub_f32 v105, v105, v60
    v_sub_f32 v106, v106, v60
    v_sub_f32 v107, v107, v60
    v_cvt_pk_bf16_f32 v24, v100, v101
    v_cvt_pk_bf16_f32 v25, v102, v103
    v_cvt_pk_bf16_f32 v26, v104, v105
    v_cvt_pk_bf16_f32 v27, v106, v107
    v_lshlrev_b32 v100, 16, v24
    v_and_b32 v101, 0xffff0000, v24
    v_lshlrev_b32 v102, 16, v25
    v_and_b32 v103, 0xffff0000, v25
    v_lshlrev_b32 v104, 16, v26
    v_and_b32 v105, 0xffff0000, v26
    v_lshlrev_b32 v106, 16, v27
    v_and_b32 v107, 0xffff0000, v27
    v_mul_f32 v100, v100, v61
    v_mul_f32 v101, v101, v61
    v_mul_f32 v102, v102, v61
    v_mul_f32 v103, v103, v61
    v_mul_f32 v104, v104, v61
    v_mul_f32 v105, v105, v61
    v_mul_f32 v106, v106, v61
    v_mul_f32 v107, v107, v61
    v_cvt_pk_bf16_f32 v24, v100, v101
    v_cvt_pk_bf16_f32 v25, v102, v103
    v_cvt_pk_bf16_f32 v26, v104, v105
    v_cvt_pk_bf16_f32 v27, v106, v107
    s_nop 1
    v_mfma_f32_16x16x32_bf16 v[64:67], v[24:27], a[128:131], 0
    v_mfma_f32_16x16x32_bf16 v[68:71], v[24:27], a[132:135], 0
    v_mfma_f32_16x16x32_bf16 v[72:75], v[24:27], a[136:139], 0
    v_mfma_f32_16x16x32_bf16 v[76:79], v[24:27], a[140:143], 0
    v_mfma_f32_16x16x32_bf16 v[80:83], v[24:27], a[144:147], 0
    v_mfma_f32_16x16x32_bf16 v[84:87], v[24:27], a[148:151], 0
    s_nop 2
    v_add_f32_dpp v56, v64, v56 quad_perm:[0,1,2,3] row_mask:0x1 bank_mask:0xf
    v_mfma_f32_16x16x32_bf16 v[88:91], v[24:27], a[152:155], 0
    v_add_f32_dpp v56, v69, v56 quad_perm:[0,1,2,3] row_mask:0x1 bank_mask:0xf
    v_mfma_f32_16x16x32_bf16 v[92:95], v[24:27], a[156:159], 0
    v_add_f32_dpp v56, v74, v56 quad_perm:[0,1,2,3] row_mask:0x1 bank_mask:0xf
    v_mfma_f32_16x16x32_bf16 v[96:99], v[24:27], a[160:163], 0
    v_add_f32_dpp v56, v79, v56 quad_perm:[0,1,2,3] row_mask:0x1 bank_mask:0xf
    v_mfma_f32_16x16x32_bf16 v[156:159], v[24:27], a[164:167], 0
    v_add_f32_dpp v56, v80, v56 quad_perm:[0,1,2,3] row_mask:0x2 bank_mask:0xf
    v_mfma_f32_16x16x32_bf16 v[160:163], v[24:27], a[168:171], 0
    v_add_f32_dpp v56, v85, v56 quad_perm:[0,1,2,3] row_mask:0x2 bank_mask:0xf
    v_mfma_f32_16x16x32_bf16 v[164:167], v[24:27], a[172:175], 0
    v_add_f32_dpp v56, v90, v56 quad_perm:[0,1,2,3] row_mask:0x2 bank_mask:0xf
    v_mfma_f32_16x16x32_bf16 v[168:171], v[24:27], a[176:179], 0
    v_add_f32_dpp v56, v95, v56 quad_perm:[0,1,2,3] row_mask:0x2 bank_mask:0xf
    v_mfma_f32_16x16x32_bf16 v[172:175], v[24:27], a[180:183], 0
    v_add_f32_dpp v56, v96, v56 quad_perm:[0,1,2,3] row_mask:0x4 bank_mask:0xf
    v_add_f32_dpp v56, v157, v56 quad_perm:[0,1,2,3] row_mask:0x4 bank_mask:0xf
    v_add_f32_dpp v56, v162, v56 quad_perm:[0,1,2,3] row_mask:0x4 bank_mask:0xf
    s_nop 0
    v_add_f32_dpp v56, v167, v56 quad_perm:[0,1,2,3] row_mask:0x4 bank_mask:0xf
    s_nop 0
    v_add_f32_dpp v56, v168, v56 quad_perm:[0,1,2,3] row_mask:0x8 bank_mask:0xf
    s_nop 0
    v_add_f32_dpp v56, v173, v56 quad_perm:[0,1,2,3] row_mask:0x8 bank_mask:0xf
    v_mov_b32 v59, v56
    s_nop 1
    v_permlane32_swap_b32 v56, v59
    v_add_f32 v56, v56, v59
    v_mov_b32 v59, v56
    s_nop 1
    v_permlane16_swap_b32 v56, v59
    v_add_f32 v56, v56, v59
    v_mul_f32 v58, 0xbfb8aa3b, v56
    v_exp_f32 v58, v58
    v_mov_b32_dpp v57, v56 row_shl:8 row_mask:0xf bank_mask:0xf
    v_add_f32 v58, 1.0, v58
    v_rcp_f32 v58, v58
    v_mul_f32 v57, v57, v56
    v_mul_f32 v56, v57, v58
    s_nop 1
    v_mov_b32_dpp v62, v56 row_shl:1 row_mask:0xf bank_mask:0xf
    v_cvt_pk_bf16_f32 v62, v56, v62
    v_min_u32 v62, -2, v62
    s_mov_b64 exec, 0x55
    s_cmp_lg_u32 s32, 0
    s_cbranch_scc0 Lslow_83
    global_store_dword v12, v62, s[26:27] offset:512
Lback_84:
    s_mov_b64 exec, -1
Lrd_72:
L_bail:
    s_endpgm
Limp_4:
    s_mov_b32 s32, 0
    v_mov_b32 v64, -1
    v_mov_b32 v65, -1
    v_mov_b32 v66, -1
    v_mov_b32 v67, -1
    s_mul_i32 s35, s28, 81920
    s_mul_i32 s36, s29, 2176
    s_add_u32 s35, s35, s36
    s_add_u32 s35, s35, 0x40000
    v_lshl_add_u32 v69, v1, 4, s35
    global_store_dwordx4 v69, v[64:67], s[26:27] sc1
    global_store_dwordx4 v69, v[64:67], s[26:27] offset:1024 sc1
    s_lshl_b32 s35, s28, 10
    s_lshl_b32 s36, s29, 3
    s_add_u32 s35, s35, s36
    s_add_u32 s35, s35, 0x4000
    v_lshl_add_u32 v69, v1, 8, s35
    s_mov_b64 exec, 0xf
    global_store_dwordx2 v69, v[64:65], s[26:27] sc1
    s_lshl_b32 s35, s28, 11
    s_lshl_b32 s36, s29, 5
    s_add_u32 s35, s35, s36
    s_add_u32 s35, s35, 0x0
    v_lshrrev_b32 v69, 1, v1
    v_lshlrev_b32 v69, 10, v69
    v_and_b32 v70, 1, v1
    v_lshl_add_u32 v69, v70, 4, v69
    v_add_u32 v69, s35, v69
    global_store_dwordx4 v69, v[64:67], s[26:27] sc1
    s_mov_b64 exec, 0xf
    s_lshl_b32 s35, s28, 10
    s_lshl_b32 s36, s29, 4
    s_add_u32 s35, s35, s36
    s_add_u32 s35, s35, 0x6000
    v_lshl_add_u32 v69, v1, 9, s35
    s_mov_b64 exec, 0x3
    global_store_dwordx4 v69, v[64:67], s[26:27] sc1
    s_lshl_b32 s35, s28, 12
    s_and_b32 s36, s29, 15
    s_lshl_b32 s36, s36, 6
    s_add_u32 s35, s35, s36
    s_add_u32 s35, s35, 0x8000
    s_cmp_lt_u32 s29, 14
    s_mov_b32 s57, 0xf000
    s_cselect_b32 s56, 0xfff, s57
    s_mov_b32 s57, 0
    s_mov_b64 exec, -1
    v_lshrrev_b32 v69, 2, v1
    v_lshlrev_b32 v69, 10, v69
    v_and_b32 v70, 3, v1
    v_lshl_add_u32 v69, v70, 4, v69
    v_add_u32 v69, s35, v69
    s_mov_b64 exec, s[56:57]
    global_store_dwordx4 v69, v[64:67], s[26:27] sc1
    s_mov_b64 exec, -1
    s_waitcnt vmcnt(0)
    s_lshl_b32 s35, s28, 2
    s_add_u32 s35, s35, 96
    v_mov_b32 v103, s35
    v_mov_b32 v70, 1
    s_mov_b64 exec, 1
    global_atomic_add v103, v70, s[24:25]
    s_mov_b64 exec, -1
    s_mov_b32 s46, 65536
Lflag2_5:
    global_load_dword v142, v141, s[24:25] offset:128 sc1
    global_load_dword v104, v103, s[24:25] sc1
    s_sub_u32 s46, s46, 1
    s_cbranch_scc1 L_bail
    s_waitcnt vmcnt(0)
    v_cmp_ne_u32 vcc, s79, v142
    s_cbranch_vccz Lrep_2
    v_cmp_gt_u32 vcc, 32, v104
    s_cbranch_vccz Lrep_2
    s_sleep 8
    s_branch Lflag2_5
Lrep_2:
    s_mov_b64 exec, 0x5555
    global_store_dword v12, v143, s[26:27] sc1
    s_mov_b64 exec, -1
    s_branch Lflaggo_6
Lslow_16:
    global_store_dwordx4 v5, v[80:83], s[26:27] offset:0 sc1
    global_store_dwordx4 v5, v[84:87], s[26:27] offset:64 sc1
    s_nop 1
    s_branch Lback_17
Lslow_19:
    global_store_dwordx2 v6, v[58:59], s[26:27] offset:0 sc1
    s_branch Lback_20
Lslow_37:
    global_store_dword v12, v67, s[26:27] offset:0 sc1
    s_branch Lback_38
Lslow_41:
    global_store_dword v12, v67, s[26:27] offset:1024 sc1
    s_branch Lback_42
Lslow_47:
    global_store_dword v12, v62, s[26:27] offset:0 sc1
    s_branch Lback_48
Lslow_52:
    global_store_dword v12, v62, s[26:27] offset:1024 sc1
    s_branch Lback_53
Lslow_58:
    global_store_dwordx4 v5, v[80:83], s[26:27] offset:1024 sc1
    global_store_dwordx4 v5, v[84:87], s[26:27] offset:1088 sc1
    s_nop 1
    s_branch Lback_59
Lslow_61:
    global_store_dwordx2 v6, v[58:59], s[26:27] offset:512 sc1
    s_branch Lback_62
Lslow_75:
    global_store_dword v12, v67, s[26:27] offset:2048 sc1
    s_branch Lback_76
Lslow_83:
    global_store_dword v12, v62, s[26:27] offset:512 sc1
    s_branch Lback_84
L_code_end:
.section .rodata,"a"
.p2align 6
.amdhsa_kernel interleave_layers__sliding_block_cached__swiglu_ffn__decode_kernel
  .amdhsa_next_free_vgpr 424
  .amdhsa_next_free_sgpr 96
  .amdhsa_accum_offset 208
  .amdhsa_group_segment_fixed_size 0
  .amdhsa_kernarg_size 96
  .amdhsa_user_sgpr_count 2
  .amdhsa_user_sgpr_kernarg_segment_ptr 1
  .amdhsa_system_sgpr_workgroup_id_x 1
  .amdhsa_float_denorm_mode_32 3
  .amdhsa_float_denorm_mode_16_64 3
.end_amdhsa_kernel
```
